```python
import torch

def _softmax(x, axis=-1):
    return torch.softmax(x, dim=axis)
def _gelu(x):
    return torch.nn.functional.gelu(x, approximate="tanh")
def _silu(x):
    return torch.nn.functional.silu(x)
def _sigmoid(x):
    return torch.sigmoid(x)
def _layernorm(x, axis=-1, eps=1e-5):
    m = x.mean(dim=axis, keepdim=True)
    v = x.var(dim=axis, keepdim=True, unbiased=False)
    return (x - m) / torch.sqrt(v + eps)
def _scatter_add(tgt, idx, src, axis=0):
    return tgt.clone().index_add_(axis, idx, src)
def _segment_sum(src, seg, n):
    out = torch.zeros((n,) + src.shape[1:], dtype=src.dtype)
    return out.index_add_(0, seg, src)
def _pad(x, pw):
    flat = tuple(v for pair in reversed(pw) for v in pair)
    return torch.nn.functional.pad(x, flat)

kernel_name = 'parallel_sum__sliding_block_cached__mixer_channel_mlp__decode'

def setup_inputs():

    _w = (lambda a: (lambda t: t.to(torch.bfloat16) if t.is_floating_point() else t)(torch.as_tensor(a)))
    def _A_setup():
        B, Sq, D = 2, 1, 1024
        Hq, Hkv, Sk, Dh = 32, 4, 16384, 128
        assert Hq % Hkv == 0, (Hq, Hkv)
        return {
            "x": _w((lambda *s: torch.randn(*s, dtype=torch.bfloat16) * 0.05)(B, Sq, D)),
            "k_cache": _w((lambda *s: torch.randn(*s, dtype=torch.bfloat16) * 3.2)(B, Hkv, Sk, Dh)),
            "v_cache": _w((lambda *s: torch.randn(*s, dtype=torch.bfloat16) * 0.4)(B, Hkv, Sk, Dh)),
            "wq": _w((lambda *s: torch.randn(*s, dtype=torch.bfloat16) * 3.2)(D, Hq * Dh) * (D ** -0.5)),
            "wo": _w((lambda *s: torch.randn(*s, dtype=torch.bfloat16) * 0.4)(Hq * Dh, D) * ((Hq * Dh) ** -0.5)),
        }
    _A_in = _A_setup()

    def _B_setup():
        B, S, D, F = 2, 1, 1024, 3584
        return {
            "x": _w((lambda *s: torch.randn(*s, dtype=torch.bfloat16) * 0.05)(B, S, D)),
            "w1": _w((lambda *s: torch.randn(*s, dtype=torch.bfloat16) * 1.6)(D, F) * (D ** -0.5)),
            "b1": _w((lambda *s: torch.randn(*s, dtype=torch.bfloat16) * 0.8)(F)),
            "w2": _w((lambda *s: torch.randn(*s, dtype=torch.bfloat16) * 0.1)(F, D) * (F ** -0.5)),
            "b2": _w((lambda *s: torch.randn(*s, dtype=torch.bfloat16) * 0.1)(D)),
        }
    _B_in = _B_setup()

    return {
        "A_x": _A_in["x"],
        "A_k_cache": _A_in["k_cache"],
        "A_v_cache": _A_in["v_cache"],
        "A_wq": _A_in["wq"],
        "A_wo": _A_in["wo"],
        "B_x": _B_in["x"],
        "B_w1": _B_in["w1"],
        "B_b1": _B_in["b1"],
        "B_w2": _B_in["w2"],
        "B_b2": _B_in["b2"],
    }

def reference(A_x, A_k_cache, A_v_cache, A_wq, A_wo, B_x, B_w1, B_b1, B_w2, B_b2):
    def _A_ref(x, k_cache, v_cache, wq, wo):
        B, Sq, D = x.shape
        Hq, Dh = 32, 128
        Hkv, Sk = k_cache.shape[1], k_cache.shape[2]
        W = min(4096, max(256, Sk // 4))
        rep = Hq // Hkv
        q = (lambda x, *d: x.permute(*d))((x @ wq).reshape(B, Sq, Hq, Dh), 0, 2, 1, 3)
        k = (lambda x, n, axis: torch.repeat_interleave(x, n, dim=axis))(k_cache[:, :, Sk - W:, :], rep, axis=1)
        v = (lambda x, n, axis: torch.repeat_interleave(x, n, dim=axis))(v_cache[:, :, Sk - W:, :], rep, axis=1)
        scores = torch.einsum("bhqd,bhkd->bhqk", q, k) * (Dh ** -0.5)
        p = _softmax(scores, axis=-1)
        o = torch.einsum("bhqk,bhkd->bhqd", p, v)
        return (lambda x, *d: x.permute(*d))(o, 0, 2, 1, 3).reshape(B, Sq, Hq * Dh) @ wo

    def _B_ref(x, w1, b1, w2, b2):
        y = _layernorm(x, axis=-1)
        h = _gelu(torch.einsum("bsd,df->bsf", y, w1) + b1)
        return torch.einsum("bsf,fd->bsd", h, w2) + b2

    x = A_x
    xn = _layernorm(x, axis=-1)
    return x + _A_ref(xn, A_k_cache, A_v_cache, A_wq, A_wo) + _B_ref(xn, B_w1, B_b1, B_w2, B_b2)
```

```asm
; @launch grid=(256,1,1) block=(448,1,1) lds=146752
.amdgcn_target "amdgcn-amd-amdhsa--gfx950"
.text
.globl parallel_sum__sliding_block_cached__mixer_channel_mlp__decode_kernel
.p2align 8
.type parallel_sum__sliding_block_cached__mixer_channel_mlp__decode_kernel,@function
parallel_sum__sliding_block_cached__mixer_channel_mlp__decode_kernel:
    s_load_dwordx2 s[8:9], s[0:1], 0
    s_load_dwordx2 s[12:13], s[0:1], 24
    v_readfirstlane_b32 s40, v0
    s_lshr_b32 s37, s2, 3
    s_cmp_ge_u32 s37, 32
    s_cbranch_scc1 L_end
    s_cmp_eq_u32 s40, 0
    s_cbranch_scc1 L_loader
    v_subrev_u32 v0, 64, v0
    s_cmpk_gt_u32 s40, 128
    s_cbranch_scc1 L_notloader
    s_getpc_b64 s[4:5]
L_pc:
    v_lshlrev_b32 v64, 7, v0
    global_load_dword v65, v64, s[4:5]
    s_branch L_notloader
L_loader:
    s_mov_b32 s15, 0x20000
    s_lshl_b32 s14, s15, 6
    s_mov_b64 s[10:11], s[14:15]
    v_lshlrev_b32 v48, 4, v0
    s_mov_b32 m0, s15
    v_lshrrev_b32 v5, 3, v0
    v_and_b32 v96, 6, v5
    v_and_b32 v6, 7, v0
    v_xor_b32 v6, v6, v96
    v_lshlrev_b32 v6, 4, v6
    v_lshl_add_u32 v49, v5, 13, v6
    s_lshr_b32 s58, s2, 5
    s_xor_b32 s58, s58, 4
    s_and_b32 s41, s2, 8
    s_or_b32 s58, s58, s41
    s_and_b32 s41, s2, 6
    s_lshl3_add_u32 s58, s41, s58
    s_bfe_u32 s43, s2, 0x10004
    s_and_b32 s41, s2, 1
    s_lshl1_add_u32 s43, s41, s43
    s_lshl_b32 s41, s43, 9
    s_add_u32 s58, s58, s41
    s_waitcnt lgkmcnt(0)
    buffer_load_dwordx4 v48, s[8:11], 0 offen offset:0 lds
    buffer_load_dwordx4 v48, s[8:11], 0 offen offset:1024 lds
    buffer_load_dwordx4 v48, s[8:11], 0 offen offset:2048 lds
    buffer_load_dwordx4 v48, s[8:11], 0 offen offset:3072 lds
    s_mov_b32 m0, 0
    s_lshl_b32 s58, s58, 7
L_pre:
    buffer_load_dwordx4 v49, s[12:15], s58 offen nt lds
    s_addk_i32 m0, 0x400
    s_lshl1_add_u32 s58, s11, s58
    buffer_load_dwordx4 v49, s[12:15], s58 offen nt lds
    s_addk_i32 m0, 0x400
    s_lshl1_add_u32 s58, s11, s58
    buffer_load_dwordx4 v49, s[12:15], s58 offen nt lds
    s_addk_i32 m0, 0x400
    s_lshl1_add_u32 s58, s11, s58
    buffer_load_dwordx4 v49, s[12:15], s58 offen nt lds
    s_addk_i32 m0, 0x400
    s_lshl1_add_u32 s58, s11, s58
    s_cmpk_lg_u32 m0, 0x8000
    s_cbranch_scc1 L_pre
L_preend:
    s_mov_b32 s56, 0
    s_and_b32 s36, s2, 7
    s_movk_i32 s10, 4096
    s_load_dwordx2 s[16:17], s[0:1], 8
    s_load_dwordx2 s[20:21], s[0:1], 16
    s_load_dwordx2 s[24:25], s[0:1], 48
    s_load_dwordx2 s[28:29], s[0:1], 32
    s_load_dwordx2 s[32:33], s[0:1], 64
    s_load_dwordx2 s[62:63], s[0:1], 96
    s_mov_b32 s52, 0
    s_mov_b32 s51, 0
    v_mov_b32 v7, 144384
    s_setprio 3
    s_barrier
    s_waitcnt vmcnt(32)
    s_add_u32 s56, s56, 4
    s_max_i32 s52, s52, s56
    v_mov_b32 v58, s52
    ds_write_b32 v7, v58 offset:24
    s_branch L_loader2
L_notloader:
    s_mov_b64 s[6:7], -1
    s_mov_b64 exec, -1
    v_and_b32 v1, 63, v0
    s_load_dwordx2 s[62:63], s[0:1], 96
    s_and_b32 s36, s2, 7
    v_mov_b32 v7, 144384
    v_mov_b32 v240, 0
    v_lshl_add_u32 v8, v1, 2, v7
    ds_write_b32 v8, v240
    s_lshr_b32 s40, s40, 6
    s_sub_u32 s40, s40, 1
    v_lshrrev_b32 v4, 6, v0
    v_lshrrev_b32 v2, 4, v1
    s_waitcnt lgkmcnt(0)
    s_load_dword s46, s[62:63], 0
    s_mov_b32 s24, s62
    s_mov_b32 s25, s63
    s_barrier
    v_lshl_add_u32 v8, v4, 2, v7
    v_and_b32 v3, 15, v1
    s_mov_b32 s26, 0x400000
    s_mov_b32 s27, 0x20000
    s_mov_b32 s48, 0xffff0000
    s_cmp_lt_u32 s40, 4
    s_cbranch_scc1 L_nodry1
    s_mov_b64 s[6:7], 0
    s_mov_b64 exec, 0
    s_cmp_eq_u32 s40, 4
    s_cbranch_scc1 L_dry4
    s_call_b64 s[60:61], L_proj
    s_branch L_dry5
L_dry4:
    s_call_b64 s[60:61], L_ln
L_dry5:
    s_mov_b64 s[6:7], -1
    s_mov_b64 exec, -1
L_nodry1:
    s_mov_b32 s51, 0
    s_mov_b32 s49, 65536
    v_lshrrev_b32 v5, 2, v3
    v_and_b32 v6, 3, v3
    v_lshlrev_b32 v6, 3, v6
    v_lshl_add_u32 v5, v2, 2, v5
    s_cmp_lt_u32 s40, 2
    s_cbranch_scc1 L_attn
    s_lshr_b32 s56, s2, 5
    s_xor_b32 s56, s56, 4
    s_and_b32 s41, s2, 8
    s_or_b32 s56, s56, s41
    s_and_b32 s41, s2, 6
    s_lshl3_add_u32 s56, s41, s56
    s_bfe_u32 s58, s2, 0x10004
    s_and_b32 s41, s2, 1
    s_lshl1_add_u32 s58, s41, s58
    s_cmp_lt_u32 s40, 4
    s_cbranch_scc1 L_isq
    s_mul_i32 s56, s36, 7
    s_lshr_b32 s41, s37, 2
    s_add_u32 s56, s56, s41
    s_add_u32 s41, s36, 56
    s_cmp_lt_u32 s37, 28
    s_cselect_b32 s56, s56, s41
    s_and_b32 s58, s37, 3
L_isq:
    v_lshrrev_b32 v97, 5, v1
    v_and_b32 v98, 31, v1
    v_lshlrev_b32 v96, 6, v98
    v_lshl_add_u32 v96, v97, 11, v96
    v_add_u32 v96, 131072, v96
    s_lshl_b32 s41, s58, 4
    v_add_u32 v104, s41, v96
    s_add_u32 s41, s41, 16
    s_and_b32 s41, s41, 63
    v_add_u32 v105, s41, v96
    s_add_u32 s41, s41, 16
    s_and_b32 s41, s41, 63
    v_add_u32 v106, s41, v96
    s_add_u32 s41, s41, 16
    s_and_b32 s41, s41, 63
    v_add_u32 v107, s41, v96
    s_cmp_lt_u32 s40, 4
    s_cselect_b32 s42, 0, 98304
    s_cselect_b32 s55, 4, 100
    s_cselect_b32 s43, 0, 1024
    s_cselect_b32 s44, 1, 0
    s_cselect_b32 s45, 14, 8
    s_add_u32 s43, s43, 139264
    v_lshlrev_b32 v21, 4, v98
    v_lshl_add_u32 v21, v97, 9, v21
    v_add_u32 v21, s43, v21
    s_movk_i32 s54, 4
L_lc10:
    ds_read_b32 v240, v7 offset:24
    s_waitcnt lgkmcnt(0)
    v_cmp_gt_i32 vcc, s54, v240
    s_cbranch_vccnz L_lc10
    ds_read_b128 v[48:51], v104
    ds_read_b128 v[52:55], v105
    ds_read_b128 v[56:59], v106
    ds_read_b128 v[60:63], v107
    s_and_b32 s41, s40, 1
    s_lshl_b32 s41, s41, 1
    v_bfe_u32 v97, v5, 1, 2
    v_xor_b32 v97, s41, v97
    v_lshl_add_u32 v22, v5, 7, v6
    v_lshl_add_u32 v22, v97, 5, v22
    v_add_u32 v22, s42, v22
    v_xor_b32 v23, 32, v22
    v_mov_b32 v38, s44
    v_and_b32 v96, 1, v3
    v_lshlrev_b32 v97, 3, v2
    v_lshl_add_u32 v20, v96, 9, v97
    v_add_u32 v20, s43, v20
    v_lshlrev_b32 v24, s45, v96
    v_lshl_add_u32 v24, v97, 1, v24
    v_bfe_u32 v96, v3, 1, 1
    v_lshl_add_u32 v24, v96, 6, v24
    s_lshl_b32 s41, s41, 6
    v_add_u32 v24, s41, v24
    s_mov_b32 s62, 0x0c0c0c0c
    s_mov_b32 s63, s62
    s_waitcnt lgkmcnt(0)
    s_add_u32 s46, s46, 9
    s_and_b32 s47, s46, 63
    s_call_b64 s[60:61], L_ln
    s_cmp_lt_u32 s40, 4
    s_cbranch_scc0 L_mlp
    s_lshr_b32 s43, s56, 4
    s_lshl_b32 s43, s43, 15
    s_and_b32 s41, s56, 15
    s_lshl_b32 s41, s41, 8
    s_add_u32 s43, s43, s41
    s_lshl_b32 s41, s58, 12
    s_add_u32 s43, s43, s41
    s_add_u32 s43, s43, 0x10000
    s_mov_b32 s32, 63
    s_mov_b32 s33, 32
    s_mov_b32 s34, s47
    s_call_b64 s[60:61], L_proj
    s_branch L_attn2
L_ln:
    v_lshlrev_b32 v64, 16, v48
    v_and_b32 v65, s48, v48
    v_lshlrev_b32 v66, 16, v49
    v_and_b32 v67, s48, v49
    v_lshlrev_b32 v68, 16, v50
    v_and_b32 v69, s48, v50
    v_lshlrev_b32 v70, 16, v51
    v_and_b32 v71, s48, v51
    v_lshlrev_b32 v72, 16, v52
    v_and_b32 v73, s48, v52
    v_lshlrev_b32 v74, 16, v53
    v_and_b32 v75, s48, v53
    v_lshlrev_b32 v76, 16, v54
    v_and_b32 v77, s48, v54
    v_lshlrev_b32 v78, 16, v55
    v_and_b32 v79, s48, v55
    v_lshlrev_b32 v80, 16, v56
    v_and_b32 v81, s48, v56
    v_lshlrev_b32 v82, 16, v57
    v_and_b32 v83, s48, v57
    v_lshlrev_b32 v84, 16, v58
    v_and_b32 v85, s48, v58
    v_lshlrev_b32 v86, 16, v59
    v_and_b32 v87, s48, v59
    v_lshlrev_b32 v88, 16, v60
    v_and_b32 v89, s48, v60
    v_lshlrev_b32 v90, 16, v61
    v_and_b32 v91, s48, v61
    v_lshlrev_b32 v92, 16, v62
    v_and_b32 v93, s48, v62
    v_lshlrev_b32 v94, 16, v63
    v_and_b32 v95, s48, v63
    v_pk_add_f32 v[96:97], v[64:65], v[66:67]
    v_pk_add_f32 v[98:99], v[68:69], v[70:71]
    v_pk_add_f32 v[96:97], v[96:97], v[72:73]
    v_pk_add_f32 v[98:99], v[98:99], v[74:75]
    v_pk_add_f32 v[96:97], v[96:97], v[76:77]
    v_pk_add_f32 v[98:99], v[98:99], v[78:79]
    v_pk_add_f32 v[96:97], v[96:97], v[80:81]
    v_pk_add_f32 v[98:99], v[98:99], v[82:83]
    v_pk_add_f32 v[96:97], v[96:97], v[84:85]
    v_pk_add_f32 v[98:99], v[98:99], v[86:87]
    v_pk_add_f32 v[96:97], v[96:97], v[88:89]
    v_pk_add_f32 v[98:99], v[98:99], v[90:91]
    v_pk_add_f32 v[96:97], v[96:97], v[92:93]
    v_pk_add_f32 v[98:99], v[98:99], v[94:95]
    v_pk_add_f32 v[96:97], v[96:97], v[98:99]
    v_add_f32 v96, v96, v97
    s_nop 1
    v_add_f32_dpp v96, v96, v96 quad_perm:[1,0,3,2] row_mask:0xf bank_mask:0xf
    s_nop 1
    v_add_f32_dpp v96, v96, v96 quad_perm:[2,3,0,1] row_mask:0xf bank_mask:0xf
    s_nop 1
    v_add_f32_dpp v96, v96, v96 row_half_mirror row_mask:0xf bank_mask:0xf
    s_nop 1
    v_add_f32_dpp v96, v96, v96 row_mirror row_mask:0xf bank_mask:0xf
    v_mov_b32 v98, v96
    s_nop 1
    v_permlane16_swap_b32 v96, v98
    v_add_f32 v96, v96, v98
    v_mul_f32 v102, 0x3a800000, v96
    v_pk_add_f32 v[136:137], v[64:65], v[102:103] op_sel_hi:[1,0] neg_lo:[0,1] neg_hi:[0,1]
    v_pk_mul_f32 v[96:97], v[136:137], v[136:137]
    v_pk_add_f32 v[138:139], v[66:67], v[102:103] op_sel_hi:[1,0] neg_lo:[0,1] neg_hi:[0,1]
    v_pk_mul_f32 v[98:99], v[138:139], v[138:139]
    v_pk_add_f32 v[140:141], v[68:69], v[102:103] op_sel_hi:[1,0] neg_lo:[0,1] neg_hi:[0,1]
    v_pk_fma_f32 v[96:97], v[140:141], v[140:141], v[96:97]
    v_pk_add_f32 v[142:143], v[70:71], v[102:103] op_sel_hi:[1,0] neg_lo:[0,1] neg_hi:[0,1]
    v_pk_fma_f32 v[98:99], v[142:143], v[142:143], v[98:99]
    v_pk_add_f32 v[136:137], v[72:73], v[102:103] op_sel_hi:[1,0] neg_lo:[0,1] neg_hi:[0,1]
    v_pk_fma_f32 v[96:97], v[136:137], v[136:137], v[96:97]
    v_pk_add_f32 v[138:139], v[74:75], v[102:103] op_sel_hi:[1,0] neg_lo:[0,1] neg_hi:[0,1]
    v_pk_fma_f32 v[98:99], v[138:139], v[138:139], v[98:99]
    v_pk_add_f32 v[140:141], v[76:77], v[102:103] op_sel_hi:[1,0] neg_lo:[0,1] neg_hi:[0,1]
    v_pk_fma_f32 v[96:97], v[140:141], v[140:141], v[96:97]
    v_pk_add_f32 v[142:143], v[78:79], v[102:103] op_sel_hi:[1,0] neg_lo:[0,1] neg_hi:[0,1]
    v_pk_fma_f32 v[98:99], v[142:143], v[142:143], v[98:99]
    v_pk_add_f32 v[136:137], v[80:81], v[102:103] op_sel_hi:[1,0] neg_lo:[0,1] neg_hi:[0,1]
    v_pk_fma_f32 v[96:97], v[136:137], v[136:137], v[96:97]
    v_pk_add_f32 v[138:139], v[82:83], v[102:103] op_sel_hi:[1,0] neg_lo:[0,1] neg_hi:[0,1]
    v_pk_fma_f32 v[98:99], v[138:139], v[138:139], v[98:99]
    v_pk_add_f32 v[140:141], v[84:85], v[102:103] op_sel_hi:[1,0] neg_lo:[0,1] neg_hi:[0,1]
    v_pk_fma_f32 v[96:97], v[140:141], v[140:141], v[96:97]
    v_pk_add_f32 v[142:143], v[86:87], v[102:103] op_sel_hi:[1,0] neg_lo:[0,1] neg_hi:[0,1]
    v_pk_fma_f32 v[98:99], v[142:143], v[142:143], v[98:99]
    v_pk_add_f32 v[136:137], v[88:89], v[102:103] op_sel_hi:[1,0] neg_lo:[0,1] neg_hi:[0,1]
    v_pk_fma_f32 v[96:97], v[136:137], v[136:137], v[96:97]
    v_pk_add_f32 v[138:139], v[90:91], v[102:103] op_sel_hi:[1,0] neg_lo:[0,1] neg_hi:[0,1]
    v_pk_fma_f32 v[98:99], v[138:139], v[138:139], v[98:99]
    v_pk_add_f32 v[140:141], v[92:93], v[102:103] op_sel_hi:[1,0] neg_lo:[0,1] neg_hi:[0,1]
    v_pk_fma_f32 v[96:97], v[140:141], v[140:141], v[96:97]
    v_pk_add_f32 v[142:143], v[94:95], v[102:103] op_sel_hi:[1,0] neg_lo:[0,1] neg_hi:[0,1]
    v_pk_fma_f32 v[98:99], v[142:143], v[142:143], v[98:99]
    v_pk_add_f32 v[96:97], v[96:97], v[98:99]
    v_add_f32 v96, v96, v97
    s_nop 1
    v_add_f32_dpp v96, v96, v96 quad_perm:[1,0,3,2] row_mask:0xf bank_mask:0xf
    s_nop 1
    v_add_f32_dpp v96, v96, v96 quad_perm:[2,3,0,1] row_mask:0xf bank_mask:0xf
    s_nop 1
    v_add_f32_dpp v96, v96, v96 row_half_mirror row_mask:0xf bank_mask:0xf
    s_nop 1
    v_add_f32_dpp v96, v96, v96 row_mirror row_mask:0xf bank_mask:0xf
    v_mov_b32 v98, v96
    s_nop 1
    v_permlane16_swap_b32 v96, v98
    v_add_f32 v96, v96, v98
    v_mul_f32 v96, 0x3a800000, v96
    v_cvt_pk_bf16_f32 v96, v96, v102
    v_and_b32 v102, s48, v96
    v_lshlrev_b32 v96, 16, v96
    v_add_f32 v96, 0x3727c5ac, v96
    v_cvt_pk_bf16_f32 v96, v96, v96
    v_lshlrev_b32 v96, 16, v96
    v_sqrt_f32 v96, v96
    s_nop 0
    v_cvt_pk_bf16_f32 v96, v96, v96
    v_lshlrev_b32 v96, 16, v96
    v_rcp_f32 v96, v96
    v_pk_add_f32 v[64:65], v[64:65], v[102:103] op_sel_hi:[1,0] neg_lo:[0,1] neg_hi:[0,1]
    v_pk_add_f32 v[66:67], v[66:67], v[102:103] op_sel_hi:[1,0] neg_lo:[0,1] neg_hi:[0,1]
    v_pk_add_f32 v[68:69], v[68:69], v[102:103] op_sel_hi:[1,0] neg_lo:[0,1] neg_hi:[0,1]
    v_pk_add_f32 v[70:71], v[70:71], v[102:103] op_sel_hi:[1,0] neg_lo:[0,1] neg_hi:[0,1]
    v_cvt_pk_bf16_f32 v48, v64, v65
    v_cvt_pk_bf16_f32 v49, v66, v67
    v_cvt_pk_bf16_f32 v50, v68, v69
    v_cvt_pk_bf16_f32 v51, v70, v71
    v_lshlrev_b32 v64, 16, v48
    v_and_b32 v65, s48, v48
    v_lshlrev_b32 v66, 16, v49
    v_and_b32 v67, s48, v49
    v_lshlrev_b32 v68, 16, v50
    v_and_b32 v69, s48, v50
    v_lshlrev_b32 v70, 16, v51
    v_and_b32 v71, s48, v51
    v_pk_mul_f32 v[64:65], v[64:65], v[96:97] op_sel_hi:[1,0]
    v_pk_mul_f32 v[66:67], v[66:67], v[96:97] op_sel_hi:[1,0]
    v_pk_mul_f32 v[68:69], v[68:69], v[96:97] op_sel_hi:[1,0]
    v_pk_mul_f32 v[70:71], v[70:71], v[96:97] op_sel_hi:[1,0]
    v_cvt_pk_bf16_f32 v48, v64, v65
    v_cvt_pk_bf16_f32 v49, v66, v67
    v_cvt_pk_bf16_f32 v50, v68, v69
    v_cvt_pk_bf16_f32 v51, v70, v71
    s_setpc_b64 s[60:61]
L_proj:
    ds_write_b128 v21, v[48:51]
    ds_read2_b64 v[104:107], v20 offset0:0 offset1:4
    ds_read2_b64 v[108:111], v20 offset0:8 offset1:12
    ds_read2_b64 v[112:115], v20 offset0:16 offset1:20
    ds_read2_b64 v[116:119], v20 offset0:24 offset1:28
    ds_read2_b64 v[120:123], v20 offset0:32 offset1:36
    ds_read2_b64 v[124:127], v20 offset0:40 offset1:44
    ds_read2_b64 v[128:131], v20 offset0:48 offset1:52
    ds_read2_b64 v[132:135], v20 offset0:56 offset1:60
    v_mov_b32 v96, s34
    s_add_u32 s54, s55, 16
L_lc43:
    ds_read_b32 v240, v7 offset:24
    s_waitcnt lgkmcnt(0)
    v_cmp_gt_i32 vcc, s54, v240
    s_cbranch_vccnz L_lc43
    ds_read_b64_tr_b16 v[136:137], v22 offset:0
    ds_read_b64_tr_b16 v[138:139], v22 offset:2048
    ds_read_b64_tr_b16 v[140:141], v23 offset:0
    ds_read_b64_tr_b16 v[142:143], v23 offset:2048
    ds_read_b64_tr_b16 v[144:145], v22 offset:4096
    ds_read_b64_tr_b16 v[146:147], v22 offset:6144
    ds_read_b64_tr_b16 v[148:149], v23 offset:4096
    ds_read_b64_tr_b16 v[150:151], v23 offset:6144
    ds_read_b64_tr_b16 v[152:153], v22 offset:8192
    ds_read_b64_tr_b16 v[154:155], v22 offset:10240
    ds_read_b64_tr_b16 v[156:157], v23 offset:8192
    ds_read_b64_tr_b16 v[158:159], v23 offset:10240
    ds_read_b64_tr_b16 v[160:161], v22 offset:12288
    ds_read_b64_tr_b16 v[162:163], v22 offset:14336
    ds_read_b64_tr_b16 v[164:165], v23 offset:12288
    ds_read_b64_tr_b16 v[166:167], v23 offset:14336
    s_waitcnt lgkmcnt(14)
    v_mfma_f32_16x16x32_bf16 v[168:171], v[136:139], v[104:107], 0
    s_waitcnt lgkmcnt(12)
    v_mfma_f32_16x16x32_bf16 v[172:175], v[140:143], v[104:107], 0
    s_waitcnt lgkmcnt(10)
    v_mfma_f32_16x16x32_bf16 v[168:171], v[144:147], v[108:111], v[168:171]
    s_waitcnt lgkmcnt(8)
    v_mfma_f32_16x16x32_bf16 v[172:175], v[148:151], v[108:111], v[172:175]
    s_waitcnt lgkmcnt(6)
    v_mfma_f32_16x16x32_bf16 v[168:171], v[152:155], v[112:115], v[168:171]
    s_waitcnt lgkmcnt(4)
    v_mfma_f32_16x16x32_bf16 v[172:175], v[156:159], v[112:115], v[172:175]
    s_waitcnt lgkmcnt(2)
    v_mfma_f32_16x16x32_bf16 v[168:171], v[160:163], v[116:119], v[168:171]
    s_waitcnt lgkmcnt(0)
    v_mfma_f32_16x16x32_bf16 v[172:175], v[164:167], v[116:119], v[172:175]
    s_add_u32 s54, s55, 28
L_lc44:
    ds_read_b32 v240, v7 offset:24
    s_waitcnt lgkmcnt(0)
    v_cmp_gt_i32 vcc, s54, v240
    s_cbranch_vccnz L_lc44
    ds_read_b64_tr_b16 v[136:137], v22 offset:16384
    ds_read_b64_tr_b16 v[138:139], v22 offset:18432
    ds_read_b64_tr_b16 v[140:141], v23 offset:16384
    ds_read_b64_tr_b16 v[142:143], v23 offset:18432
    ds_read_b64_tr_b16 v[144:145], v22 offset:20480
    ds_read_b64_tr_b16 v[146:147], v22 offset:22528
    ds_read_b64_tr_b16 v[148:149], v23 offset:20480
    ds_read_b64_tr_b16 v[150:151], v23 offset:22528
    ds_read_b64_tr_b16 v[152:153], v22 offset:24576
    ds_read_b64_tr_b16 v[154:155], v22 offset:26624
    ds_read_b64_tr_b16 v[156:157], v23 offset:24576
    ds_read_b64_tr_b16 v[158:159], v23 offset:26624
    s_waitcnt lgkmcnt(10)
    v_mfma_f32_16x16x32_bf16 v[168:171], v[136:139], v[120:123], v[168:171]
    s_waitcnt lgkmcnt(8)
    v_mfma_f32_16x16x32_bf16 v[172:175], v[140:143], v[120:123], v[172:175]
    s_waitcnt lgkmcnt(6)
    v_mfma_f32_16x16x32_bf16 v[168:171], v[144:147], v[124:127], v[168:171]
    s_waitcnt lgkmcnt(4)
    v_mfma_f32_16x16x32_bf16 v[172:175], v[148:151], v[124:127], v[172:175]
    s_waitcnt lgkmcnt(2)
    v_mfma_f32_16x16x32_bf16 v[168:171], v[152:155], v[128:131], v[168:171]
    s_waitcnt lgkmcnt(0)
    v_mfma_f32_16x16x32_bf16 v[172:175], v[156:159], v[128:131], v[172:175]
    s_add_u32 s54, s55, 32
L_lc45:
    ds_read_b32 v240, v7 offset:24
    s_waitcnt lgkmcnt(0)
    v_cmp_gt_i32 vcc, s54, v240
    s_cbranch_vccnz L_lc45
    ds_read_b64_tr_b16 v[136:137], v22 offset:28672
    ds_read_b64_tr_b16 v[138:139], v22 offset:30720
    ds_read_b64_tr_b16 v[140:141], v23 offset:28672
    ds_read_b64_tr_b16 v[142:143], v23 offset:30720
    ds_write_b32 v8, v38
    s_waitcnt lgkmcnt(3)
    v_mfma_f32_16x16x32_bf16 v[168:171], v[136:139], v[132:135], v[168:171]
    s_waitcnt lgkmcnt(1)
    v_mfma_f32_16x16x32_bf16 v[172:175], v[140:143], v[132:135], v[172:175]
    s_nop 7
    v_cndmask_b32 v168, v168, v172, s[62:63]
    v_cndmask_b32 v169, v169, v173, s[62:63]
    v_cndmask_b32 v170, v170, v174, s[62:63]
    v_cndmask_b32 v171, v171, v175, s[62:63]
    v_add_u32 v168, s33, v168
    v_add_u32 v169, s33, v169
    v_add_u32 v170, s33, v170
    v_add_u32 v171, s33, v171
    v_bfi_b32 v168, s32, v96, v168
    v_bfi_b32 v169, s32, v96, v169
    v_bfi_b32 v170, s32, v96, v170
    v_bfi_b32 v171, s32, v96, v171
    s_and_b32 exec_lo, s6, 0xf000f
    s_mov_b32 exec_hi, exec_lo
    s_cbranch_execz L_pjdone
    s_cmp_lt_u32 s40, 4
    s_cbranch_scc0 L_pjloc
    buffer_store_dwordx4 v[168:171], v24, s[24:27], s43 offen sc1
    s_branch L_pjdone
L_pjloc:
    buffer_store_dwordx4 v[168:171], v24, s[24:27], s43 offen
L_pjdone:
    s_mov_b64 exec, s[6:7]
    s_setpc_b64 s[60:61]
L_loader2:
    v_mov_b32 v1, v0
    v_lshrrev_b32 v2, 4, v1
    v_and_b32 v3, 15, v1
    v_mul_u32_u24 v50, 7168, v5
    v_add_u32 v50, v50, v6
    v_lshlrev_b32 v5, 8, v2
    v_xor_b32 v6, v3, v2
    v_lshl_add_u32 v52, v6, 4, v5
    v_xor_b32 v53, 64, v52
    v_xor_b32 v54, 128, v52
    v_xor_b32 v55, 192, v52
    v_xor_b32 v6, v3, v96
    v_lshl_add_u32 v56, v6, 4, v5
    v_xor_b32 v57, 128, v56
    s_mov_b32 s18, 0x2000000
    s_mov_b32 s22, s18
    s_mov_b32 s30, s14
    s_mov_b32 s19, 0x20000
    s_mov_b32 s23, 0x20000
    s_mov_b32 s27, 0x20000
    s_mov_b32 s31, 0x20000
    s_mov_b32 s35, 0x20000
    s_cmp_lt_u32 s37, 28
    s_cselect_b32 s26, 7340032, 0
    s_mov_b32 s34, s26
    s_and_b32 s44, s36, 1
    s_lshl_b32 s44, s44, 2
    s_lshr_b32 s41, s36, 1
    s_add_u32 s44, s44, s41
    s_lshl_b32 s44, s44, 22
    s_add_u32 s44, s44, 0x300000
    s_waitcnt lgkmcnt(0)
    s_load_dword s46, s[62:63], 0
    s_waitcnt vmcnt(28)
    s_add_u32 s56, s56, 4
    s_max_i32 s52, s52, s56
    v_mov_b32 v58, s52
    ds_write_b32 v7, v58 offset:24
    s_waitcnt vmcnt(24)
    s_add_u32 s56, s56, 4
    s_max_i32 s52, s52, s56
    v_mov_b32 v58, s52
    ds_write_b32 v7, v58 offset:24
    s_waitcnt vmcnt(20)
    s_add_u32 s56, s56, 4
    s_max_i32 s52, s52, s56
    v_mov_b32 v58, s52
    ds_write_b32 v7, v58 offset:24
    s_mov_b32 s42, s44
    s_lshl_b32 s57, s37, 12
L_ld1:
    s_and_b32 s57, s57, 0x1ffff
    s_add_u32 s58, s42, s57
    s_add_u32 s57, s57, 20480
    s_add_u32 s42, s42, 131072
    s_waitcnt vmcnt(19)
    buffer_load_dwordx4 v52, s[16:19], s58 offen offset:0 nt lds
    s_waitcnt vmcnt(19)
    buffer_load_dwordx4 v53, s[16:19], s58 offen offset:1024 nt lds
    s_waitcnt vmcnt(19)
    buffer_load_dwordx4 v54, s[16:19], s58 offen offset:2048 nt lds
    s_waitcnt vmcnt(19)
    buffer_load_dwordx4 v55, s[16:19], s58 offen offset:3072 nt lds
    s_add_u32 m0, m0, 4096
    s_add_u32 s56, s56, 4
    s_max_i32 s52, s52, s56
    v_mov_b32 v58, s52
    ds_write_b32 v7, v58 offset:24
    s_cmp_lg_u32 s56, 48
    s_cbranch_scc1 L_ld1
    s_waitcnt lgkmcnt(0)
    s_mov_b32 s42, s44
    s_lshl_b32 s57, s37, 12
L_ld2:
    s_and_b32 s57, s57, 0x1ffff
    s_add_u32 s58, s42, s57
    s_add_u32 s57, s57, 20480
    s_add_u32 s42, s42, 131072
    s_waitcnt vmcnt(19)
    buffer_load_dwordx4 v56, s[20:23], s58 offen offset:0 nt lds
    s_waitcnt vmcnt(19)
    buffer_load_dwordx4 v57, s[20:23], s58 offen offset:1024 nt lds
    s_waitcnt vmcnt(19)
    buffer_load_dwordx4 v56, s[20:23], s58 offen offset:2048 nt lds
    s_waitcnt vmcnt(19)
    buffer_load_dwordx4 v57, s[20:23], s58 offen offset:3072 nt lds
    s_add_u32 m0, m0, 4096
    s_add_u32 s56, s56, 4
    s_max_i32 s52, s52, s56
    v_mov_b32 v58, s52
    ds_write_b32 v7, v58 offset:24
    s_cmp_lg_u32 s56, 80
    s_cbranch_scc1 L_ld2
    s_mul_i32 s39, s36, 7
    s_lshr_b32 s41, s37, 2
    s_add_u32 s39, s39, s41
    s_add_u32 s41, s36, 56
    s_cmp_lt_u32 s37, 28
    s_cselect_b32 s39, s39, s41
    s_and_b32 s43, s37, 3
    s_lshl_b32 s58, s39, 7
    s_mul_i32 s41, s43, 57344
    s_add_u32 s58, s58, s41
    s_lshl_b32 s43, s43, 9
L_ld3:
    s_waitcnt vmcnt(19)
    buffer_load_dwordx4 v50, s[24:27], s58 offen nt lds
    s_add_u32 m0, m0, 1024
    s_add_u32 s58, s58, 229376
    s_waitcnt vmcnt(19)
    buffer_load_dwordx4 v50, s[24:27], s58 offen nt lds
    s_add_u32 m0, m0, 1024
    s_add_u32 s58, s58, 229376
    s_waitcnt vmcnt(19)
    buffer_load_dwordx4 v50, s[24:27], s58 offen nt lds
    s_add_u32 m0, m0, 1024
    s_add_u32 s58, s58, 229376
    s_waitcnt vmcnt(19)
    buffer_load_dwordx4 v50, s[24:27], s58 offen nt lds
    s_add_u32 m0, m0, 1024
    s_add_u32 s58, s58, 229376
    s_add_u32 s56, s56, 4
    s_max_i32 s52, s52, s56
    v_mov_b32 v58, s52
    ds_write_b32 v7, v58 offset:24
    s_cmp_lg_u32 s56, 112
    s_cbranch_scc1 L_ld3
    v_lshrrev_b32 v5, 5, v1
    v_and_b32 v6, 31, v1
    v_lshlrev_b32 v52, 1, v5
    v_xor_b32 v6, v6, v52
    v_lshlrev_b32 v6, 4, v6
    v_lshl_add_u32 v52, v5, 11, v6
    v_xor_b32 v53, 64, v52
    v_xor_b32 v54, 128, v52
    v_xor_b32 v55, 192, v52
    s_lshl_b32 s38, s36, 5
    s_add_u32 s38, s38, s37
    s_lshr_b32 s59, s37, 2
L_pw4:
    ds_read_b128 v[240:243], v7
    s_waitcnt lgkmcnt(0)
    v_min3_i32 v240, v240, v241, v242
    v_min_i32 v240, v240, v243
    v_cmp_gt_i32 vcc, 1, v240
    s_cbranch_vccnz L_pw4
    s_lshr_b32 s41, s38, 4
    s_lshl_b32 s41, s41, 19
    s_and_b32 s42, s59, 3
    s_lshl_b32 s42, s42, 16
    s_add_u32 s41, s41, s42
    s_add_u32 s41, s41, s43
    s_mov_b32 s53, 0
L_ld5:
    s_add_u32 s57, s53, s59
    s_and_b32 s57, s57, 3
    s_xor_b32 s42, s53, s59
    s_bfe_u32 s42, s42, 0x10002
    s_lshl_b32 s58, s42, 18
    s_add_u32 s58, s58, s41
    s_lshl_b32 s45, s57, 14
    s_add_u32 s58, s58, s45
    s_lshl_b32 s42, s42, 2
    s_add_u32 s57, s57, s42
    s_lshl_b32 s57, s57, 12
    s_add_u32 m0, s57, 0
    s_add_u32 s53, s53, 1
    s_waitcnt vmcnt(19)
    buffer_load_dwordx4 v52, s[28:31], s58 offen nt lds
    s_add_u32 m0, m0, 1024
    s_add_u32 s58, s58, 4096
    s_waitcnt vmcnt(19)
    buffer_load_dwordx4 v53, s[28:31], s58 offen nt lds
    s_add_u32 m0, m0, 1024
    s_add_u32 s58, s58, 4096
    s_waitcnt vmcnt(19)
    buffer_load_dwordx4 v54, s[28:31], s58 offen nt lds
    s_add_u32 m0, m0, 1024
    s_add_u32 s58, s58, 4096
    s_waitcnt vmcnt(19)
    buffer_load_dwordx4 v55, s[28:31], s58 offen nt lds
    s_add_u32 s56, s56, 4
    s_max_i32 s52, s52, s56
    v_mov_b32 v58, s52
    ds_write_b32 v7, v58 offset:24
    s_cmp_lg_u32 s56, 144
    s_cbranch_scc1 L_ld5
L_pw6:
    ds_read_b128 v[240:243], v7
    s_waitcnt lgkmcnt(0)
    v_min3_i32 v240, v240, v241, v242
    v_min_i32 v240, v240, v243
    v_cmp_gt_i32 vcc, 3, v240
    s_cbranch_vccnz L_pw6
    s_lshl_b32 s41, s39, 17
    s_add_u32 s41, s41, s43
    s_mov_b32 s53, 0
L_aa7:
    ds_read_b128 v[240:243], v7
    s_add_u32 s57, s53, s59
    s_and_b32 s57, s57, 3
    s_xor_b32 s42, s53, s59
    s_bfe_u32 s42, s42, 0x10002
    s_lshl_b32 s58, s42, 16
    s_add_u32 s58, s58, s41
    s_lshl_b32 s45, s57, 14
    s_add_u32 s58, s58, s45
    s_lshl_b32 s42, s42, 2
    s_add_u32 s57, s57, s42
    s_lshl_b32 s57, s57, 12
    s_add_u32 m0, s57, 32768
    s_add_u32 s53, s53, 1
    s_waitcnt vmcnt(19)
    buffer_load_dwordx4 v52, s[32:35], s58 offen nt lds
    s_add_u32 m0, m0, 1024
    s_add_u32 s58, s58, 4096
    s_waitcnt vmcnt(19)
    buffer_load_dwordx4 v53, s[32:35], s58 offen nt lds
    s_add_u32 m0, m0, 1024
    s_add_u32 s58, s58, 4096
    s_waitcnt vmcnt(19)
    buffer_load_dwordx4 v54, s[32:35], s58 offen nt lds
    s_add_u32 m0, m0, 1024
    s_add_u32 s58, s58, 4096
    s_waitcnt vmcnt(19)
    buffer_load_dwordx4 v55, s[32:35], s58 offen nt lds
    s_add_u32 s56, s56, 4
    s_max_i32 s52, s52, s56
    v_mov_b32 v58, s52
    ds_write_b32 v7, v58 offset:24
    s_cmp_eq_u32 s56, 176
    s_cbranch_scc1 L_ad8
    s_waitcnt lgkmcnt(1)
    v_min3_i32 v240, v240, v241, v242
    v_min_i32 v240, v240, v243
    v_cmp_gt_i32 vcc, 7, v240
    s_cbranch_vccnz L_aa7
    s_sub_u32 s56, s56, 20
L_ld9:
    s_add_u32 s57, s53, s59
    s_and_b32 s57, s57, 3
    s_xor_b32 s42, s53, s59
    s_bfe_u32 s42, s42, 0x10002
    s_lshl_b32 s58, s42, 16
    s_add_u32 s58, s58, s41
    s_lshl_b32 s45, s57, 14
    s_add_u32 s58, s58, s45
    s_lshl_b32 s42, s42, 2
    s_add_u32 s57, s57, s42
    s_lshl_b32 s57, s57, 12
    s_add_u32 m0, s57, 32768
    s_add_u32 s53, s53, 1
    s_waitcnt vmcnt(39)
    buffer_load_dwordx4 v52, s[32:35], s58 offen nt lds
    s_add_u32 m0, m0, 1024
    s_add_u32 s58, s58, 4096
    s_waitcnt vmcnt(39)
    buffer_load_dwordx4 v53, s[32:35], s58 offen nt lds
    s_add_u32 m0, m0, 1024
    s_add_u32 s58, s58, 4096
    s_waitcnt vmcnt(39)
    buffer_load_dwordx4 v54, s[32:35], s58 offen nt lds
    s_add_u32 m0, m0, 1024
    s_add_u32 s58, s58, 4096
    s_waitcnt vmcnt(39)
    buffer_load_dwordx4 v55, s[32:35], s58 offen nt lds
    s_add_u32 s56, s56, 4
    s_max_i32 s52, s52, s56
    v_mov_b32 v58, s52
    ds_write_b32 v7, v58 offset:24
    s_cmp_lg_u32 s56, 156
    s_cbranch_scc1 L_ld9
    s_waitcnt vmcnt(36)
    s_add_u32 s56, s56, 4
    s_max_i32 s52, s52, s56
    v_mov_b32 v58, s52
    ds_write_b32 v7, v58 offset:24
    s_waitcnt vmcnt(32)
    s_add_u32 s56, s56, 4
    s_max_i32 s52, s52, s56
    v_mov_b32 v58, s52
    ds_write_b32 v7, v58 offset:24
    s_waitcnt vmcnt(28)
    s_add_u32 s56, s56, 4
    s_max_i32 s52, s52, s56
    v_mov_b32 v58, s52
    ds_write_b32 v7, v58 offset:24
    s_waitcnt vmcnt(24)
    s_add_u32 s56, s56, 4
    s_max_i32 s52, s52, s56
    v_mov_b32 v58, s52
    ds_write_b32 v7, v58 offset:24
    s_waitcnt vmcnt(20)
    s_add_u32 s56, s56, 4
    s_max_i32 s52, s52, s56
    v_mov_b32 v58, s52
    ds_write_b32 v7, v58 offset:24
L_ad8:
    s_load_dwordx2 s[16:17], s[0:1], 72
    s_load_dwordx2 s[20:21], s[0:1], 80
    s_mov_b32 s12, s62
    s_mov_b32 s13, s63
    s_mov_b32 s14, 0x400000
    s_movk_i32 s18, 2048
    s_movk_i32 s22, 4096
    v_and_b32 v5, 1, v1
    v_lshlrev_b32 v60, 3, v5
    v_lshrrev_b32 v6, 1, v1
    v_lshlrev_b32 v61, 4, v5
    v_lshl_add_u32 v61, v6, 11, v61
    s_lshr_b32 s41, s38, 6
    s_lshl_b32 s43, s41, 9
    s_and_b32 s42, s38, 31
    s_lshl_b32 s42, s42, 4
    s_add_u32 s43, s43, s42
    s_bfe_u32 s42, s38, 0x10005
    s_lshl_b32 s42, s42, 11
    s_add_u32 s57, s43, s42
    s_lshl_b32 s41, s41, 17
    s_and_b32 s42, s38, 63
    s_lshl_b32 s42, s42, 5
    s_add_u32 s41, s41, s42
    s_add_u32 s41, s41, 0x200000
    s_add_u32 s42, s41, 65536
    s_add_u32 s46, s46, 9
    s_and_b32 s47, s46, 0xfff
    s_mov_b32 s48, 0xffff0000
    s_mov_b32 s49, 65536
    s_waitcnt vmcnt(16)
    s_add_u32 s56, s56, 4
    s_max_i32 s52, s52, s56
    v_mov_b32 v58, s52
    ds_write_b32 v7, v58 offset:24
    s_waitcnt vmcnt(12)
    s_add_u32 s56, s56, 4
    s_max_i32 s52, s52, s56
    v_mov_b32 v58, s52
    ds_write_b32 v7, v58 offset:24
    s_waitcnt vmcnt(8)
    s_add_u32 s56, s56, 4
    s_max_i32 s52, s52, s56
    v_mov_b32 v58, s52
    ds_write_b32 v7, v58 offset:24
    s_waitcnt vmcnt(4)
    s_add_u32 s56, s56, 4
    s_max_i32 s52, s52, s56
    v_mov_b32 v58, s52
    ds_write_b32 v7, v58 offset:24
    s_waitcnt vmcnt(0)
    s_add_u32 s56, s56, 4
    s_max_i32 s52, s52, s56
    v_mov_b32 v58, s52
    ds_write_b32 v7, v58 offset:24
    s_waitcnt lgkmcnt(0)
    buffer_load_dwordx2 v[232:233], v60, s[8:11], s57 offen
    buffer_load_dwordx2 v[234:235], v60, s[16:19], s43 offen
L_g3:
    buffer_load_dwordx4 v[216:219], v61, s[12:15], s41 offen sc1
    buffer_load_dwordx4 v[220:223], v61, s[12:15], s42 offen sc1
    s_add_u32 s51, s51, 0x1000000
    s_sub_u32 s49, s49, 1
    s_cbranch_scc1 L_end
    s_waitcnt vmcnt(0)
    v_xor_b32 v216, s47, v216
    v_xor_b32 v217, s47, v217
    v_xor_b32 v218, s47, v218
    v_xor_b32 v219, s47, v219
    v_xor_b32 v220, s47, v220
    v_xor_b32 v221, s47, v221
    v_xor_b32 v222, s47, v222
    v_xor_b32 v223, s47, v223
    v_or3_b32 v96, v216, v217, v218
    v_or3_b32 v96, v96, v219, v220
    v_or3_b32 v96, v96, v221, v222
    v_or_b32 v96, v96, v223
    v_and_b32 v96, 0xfff, v96
    v_cmp_ne_u32 vcc, 0, v96
    s_nop 0
    s_and_b64 exec, exec, vcc
    s_cbranch_scc1 L_g3
    s_mov_b64 exec, -1
    v_pk_add_f32 v[216:217], v[216:217], v[220:221]
    v_pk_add_f32 v[218:219], v[218:219], v[222:223]
    v_lshlrev_b32 v200, 16, v232
    v_and_b32 v201, s48, v232
    v_lshlrev_b32 v202, 16, v233
    v_and_b32 v203, s48, v233
    v_permlane32_swap_b32 v216, v218
    v_permlane32_swap_b32 v217, v219
    v_lshlrev_b32 v204, 16, v234
    v_and_b32 v205, s48, v234
    v_pk_add_f32 v[216:217], v[216:217], v[218:219]
    v_lshlrev_b32 v206, 16, v235
    v_and_b32 v207, s48, v235
    v_permlane16_swap_b32 v216, v217
    v_pk_add_f32 v[200:201], v[200:201], v[204:205]
    v_add_f32 v216, v216, v217
    v_pk_add_f32 v[202:203], v[202:203], v[206:207]
    s_mov_b32 vcc_lo, 0xffff0000
    s_mov_b32 vcc_hi, 0xffff0000
    v_add_f32_dpp v216, v216, v216 row_ror:2 row_mask:0xf bank_mask:0xf
    v_cndmask_b32 v200, v200, v201, vcc
    v_cndmask_b32 v202, v202, v203, vcc
    v_add_f32_dpp v216, v216, v216 row_ror:4 row_mask:0xf bank_mask:0xf
    s_mov_b32 vcc_lo, 0
    s_mov_b32 vcc_hi, -1
    v_cndmask_b32 v200, v200, v202, vcc
    v_add_f32_dpp v216, v216, v216 row_ror:8 row_mask:0xf bank_mask:0xf
    v_lshrrev_b32 v5, 4, v1
    v_lshl_add_u32 v60, v5, 1, v60
    v_add_f32 v200, v200, v216
    v_cvt_pk_bf16_f32 v200, v200, v200
    s_mov_b32 exec_lo, 0x00030003
    s_mov_b32 exec_hi, 0x00030003
    buffer_store_short v200, v60, s[20:23], s57 offen
    s_cmp_lg_u32 s2, 0
    s_cbranch_scc1 L_lend
    v_mov_b32 v96, s46
    v_mov_b32 v97, 0
    s_mov_b64 exec, 1
    buffer_store_dword v96, v97, s[12:15], 0 offen
L_lend:
L_end:
    s_endpgm
L_attn:
    v_mov_b32 v240, 1
    ds_write_b32 v8, v240
    s_waitcnt lgkmcnt(0)
    s_add_u32 s46, s46, 9
    s_and_b32 s47, s46, 63
L_attn2:
    s_lshl_b32 s38, s36, 5
    s_add_u32 s38, s38, s37
    s_lshl_b32 s52, s40, 3
    s_add_u32 s52, s52, 8
    s_bfe_u32 s59, s37, 0x10004
    s_lshl_b32 s41, s59, 14
    v_and_b32 v96, 7, v5
    v_lshlrev_b32 v98, 2, v4
    v_xor_b32 v97, v96, v98
    v_lshl_add_u32 v9, v5, 9, v6
    v_lshl_add_u32 v9, v97, 5, v9
    v_add_u32 v9, s41, v9
    v_xor_b32 v10, 32, v9
    v_xor_b32 v11, 64, v9
    v_xor_b32 v12, 96, v9
    v_lshlrev_b32 v98, 1, v4
    v_xor_b32 v97, v96, v98
    v_lshl_add_u32 v17, v5, 8, v6
    v_lshl_add_u32 v17, v97, 5, v17
    v_add_u32 v17, 65536, v17
    v_xor_b32 v18, 32, v17
    v_xor_b32 v97, v2, v3
    v_lshlrev_b32 v97, 4, v97
    v_lshl_add_u32 v97, v3, 8, v97
    v_lshl_add_u32 v97, v4, 13, v97
    v_add_u32 v13, 32768, v97
    v_xor_b32 v14, 64, v13
    v_xor_b32 v15, 128, v13
    v_xor_b32 v16, 192, v13
    v_and_b32 v97, 7, v3
    v_mul_u32_u24 v19, 272, v97
    v_lshl_add_u32 v19, v2, 4, v19
    v_add_u32 v19, 141312, v19
    v_lshlrev_b32 v32, 3, v97
    v_add_u32 v30, 143616, v32
    v_lshl_add_u32 v29, v4, 6, v30
    v_lshlrev_b32 v31, 6, v97
    v_lshl_add_u32 v31, v4, 9, v31
    v_lshl_add_u32 v31, v2, 4, v31
    v_lshlrev_b32 v25, 4, v0
    v_add_u32 v27, 135168, v25
    v_lshlrev_b32 v28, 4, v1
    v_add_u32 v28, 135168, v28
    v_lshrrev_b32 v97, 5, v0
    v_and_b32 v98, 31, v0
    v_mul_u32_u24 v26, 272, v97
    v_lshl_add_u32 v26, v98, 3, v26
    v_add_u32 v26, 141312, v26
    v_lshrrev_b32 v96, 3, v1
    v_and_b32 v97, 7, v1
    v_lshlrev_b32 v98, 4, v97
    v_lshl_add_u32 v33, v96, 11, v98
    v_lshrrev_b32 v97, 2, v97
    v_lshlrev_b32 v97, 3, v97
    v_lshl_add_u32 v34, v96, 8, v97
    v_lshl_add_u32 v36, v96, 1, v98
    s_xor_b32 s41, s40, s36
    s_and_b32 s41, s41, 1
    s_lshl_b32 s41, s41, 7
    s_add_u32 s41, s41, 143872
    v_add_u32 v36, s41, v36
    v_and_b32 v96, 7, v1
    v_xor_b32 v96, s46, v96
    v_bfe_u32 v43, v96, 0, 1
    v_bfe_u32 v44, v96, 1, 1
    v_bfe_u32 v45, v96, 2, 1
    v_bfe_u32 v46, v96, 3, 1
    v_and_b32 v97, 1, v1
    v_lshlrev_b32 v37, 4, v2
    v_lshl_add_u32 v37, v97, 7, v37
    s_lshl_b32 s41, s59, 6
    s_add_u32 s41, s41, 143872
    v_add_u32 v37, s41, v37
    v_lshlrev_b32 v35, 10, v97
    v_lshl_add_u32 v35, v4, 8, v35
    v_lshl_add_u32 v35, v2, 4, v35
    v_bfe_u32 v98, v1, 1, 2
    v_lshl_add_u32 v35, v98, 6, v35
    s_mov_b32 s62, 0xc0c0c0c
    s_mov_b32 s63, s62
    s_mov_b32 s64, 0x30303030
    s_mov_b32 s65, s64
    s_mov_b32 s66, 0xc0c0c0c0
    s_mov_b32 s67, s66
    v_and_b32 v96, 1, v1
    v_lshl_add_u32 v96, v96, 2, v2
    v_xor_b32 v96, s46, v96
    v_bfe_u32 v39, v96, 0, 1
    v_bfe_u32 v40, v96, 1, 1
    v_bfe_u32 v41, v96, 2, 1
    v_bfe_u32 v42, v96, 3, 1
    s_getreg_b32 s34, hwreg(HW_REG_XCC_ID, 0, 3)
    s_and_b32 s41, s46, -8
    s_or_b32 s34, s34, s41
    s_cmp_ge_u32 s40, 2
    s_cbranch_scc1 L_partA
    s_mov_b64 s[6:7], 0
    s_mov_b64 exec, 0
    s_cmp_eq_u32 s40, 1
    s_cbranch_scc1 L_partB
    s_branch L_partA
L_areal:
    s_mov_b64 s[6:7], -1
    s_mov_b64 exec, -1
L_partA:
    s_lshl_b32 s41, s36, 14
    s_add_u32 s41, s41, 0x10000
    s_add_u32 s42, s41, 4096
    s_add_u32 s43, s41, 8192
    s_add_u32 s44, s41, 12288
    s_add_u32 s54, s52, 36
L_lc20:
    ds_read_b32 v240, v7 offset:24
    s_waitcnt lgkmcnt(0)
    v_cmp_gt_i32 vcc, s54, v240
    s_cbranch_vccnz L_lc20
    ds_read_b128 v[104:107], v13 offset:0
    ds_read_b128 v[108:111], v14 offset:0
    ds_read_b128 v[112:115], v15 offset:0
    ds_read_b128 v[116:119], v16 offset:0
    ds_read_b128 v[120:123], v13 offset:4096
    ds_read_b128 v[124:127], v14 offset:4096
    ds_read_b128 v[128:131], v15 offset:4096
    ds_read_b128 v[132:135], v16 offset:4096
    s_cmp_lt_u32 s37, 28
    s_cselect_b32 s57, 0, 0
    s_add_u32 s54, s57, 76
L_lc21:
    ds_read_b32 v240, v7 offset:24
    s_waitcnt lgkmcnt(0)
    v_cmp_gt_i32 vcc, s54, v240
    s_cbranch_vccnz L_lc21
    s_cbranch_execz L_vm22
    buffer_load_dwordx4 v[216:219], v25, s[24:27], s41 offen sc1
    buffer_load_dwordx4 v[220:223], v25, s[24:27], s42 offen sc1
    buffer_load_dwordx4 v[224:227], v25, s[24:27], s43 offen sc1
    buffer_load_dwordx4 v[228:231], v25, s[24:27], s44 offen sc1
L_vm22:
    v_mov_b32 v240, 3
    ds_write_b32 v8, v240
    v_mov_b32 v100, 0x3db504f3
    v_mov_b32 v102, 0x3fb8aa3b
    s_waitcnt vmcnt(0)
L_g1chk:
    v_xor_b32 v216, s47, v216
    v_xor_b32 v217, s47, v217
    v_xor_b32 v218, s47, v218
    v_xor_b32 v219, s47, v219
    v_xor_b32 v220, s47, v220
    v_xor_b32 v221, s47, v221
    v_xor_b32 v222, s47, v222
    v_xor_b32 v223, s47, v223
    v_xor_b32 v224, s47, v224
    v_xor_b32 v225, s47, v225
    v_xor_b32 v226, s47, v226
    v_xor_b32 v227, s47, v227
    v_xor_b32 v228, s47, v228
    v_xor_b32 v229, s47, v229
    v_xor_b32 v230, s47, v230
    v_xor_b32 v231, s47, v231
    v_or3_b32 v96, v216, v217, v218
    v_or3_b32 v96, v96, v219, v220
    v_or3_b32 v96, v96, v221, v222
    v_or3_b32 v96, v96, v223, v224
    v_or3_b32 v96, v96, v225, v226
    v_or3_b32 v96, v96, v227, v228
    v_or3_b32 v96, v96, v229, v230
    v_or_b32 v96, v96, v231
    v_and_b32 v96, 63, v96
    v_cmp_ne_u32 vcc, 0, v96
    s_cbranch_vccz L_g1ok
    s_add_u32 s51, s51, 1
    s_sub_u32 s49, s49, 1
    s_cbranch_scc1 L_bail
    s_cbranch_execz L_vm23
    buffer_load_dwordx4 v[216:219], v25, s[24:27], s41 offen sc1
    buffer_load_dwordx4 v[220:223], v25, s[24:27], s42 offen sc1
    buffer_load_dwordx4 v[224:227], v25, s[24:27], s43 offen sc1
    buffer_load_dwordx4 v[228:231], v25, s[24:27], s44 offen sc1
L_vm23:
    s_waitcnt vmcnt(0)
    s_branch L_g1chk
L_g1ok:
    v_pk_add_f32 v[216:217], v[216:217], v[220:221]
    v_pk_add_f32 v[224:225], v[224:225], v[228:229]
    v_pk_add_f32 v[218:219], v[218:219], v[222:223]
    v_pk_add_f32 v[226:227], v[226:227], v[230:231]
    v_pk_add_f32 v[216:217], v[216:217], v[224:225]
    v_pk_add_f32 v[218:219], v[218:219], v[226:227]
    v_cvt_pk_bf16_f32 v216, v216, v217
    v_cvt_pk_bf16_f32 v217, v218, v219
    ds_write_b64 v26, v[216:217]
    v_mov_b32 v240, 4
    ds_write_b32 v8, v240
L_pw24:
    ds_read_b128 v[240:243], v7
    s_waitcnt lgkmcnt(0)
    v_min3_i32 v240, v240, v241, v242
    v_min_i32 v240, v240, v243
    v_cmp_gt_i32 vcc, 4, v240
    s_cbranch_vccnz L_pw24
    ds_read_b128 v[200:203], v19 offset:0
    ds_read_b128 v[204:207], v19 offset:64
    ds_read_b128 v[208:211], v19 offset:128
    ds_read_b128 v[212:215], v19 offset:192
    s_waitcnt lgkmcnt(3)
    v_mfma_f32_16x16x32_bf16 v[64:67], v[104:107], v[200:203], 0
    v_mfma_f32_16x16x32_bf16 v[68:71], v[120:123], v[200:203], 0
    s_waitcnt lgkmcnt(2)
    v_mfma_f32_16x16x32_bf16 v[64:67], v[108:111], v[204:207], v[64:67]
    v_mfma_f32_16x16x32_bf16 v[68:71], v[124:127], v[204:207], v[68:71]
    s_waitcnt lgkmcnt(1)
    v_mfma_f32_16x16x32_bf16 v[64:67], v[112:115], v[208:211], v[64:67]
    v_mfma_f32_16x16x32_bf16 v[68:71], v[128:131], v[208:211], v[68:71]
    s_waitcnt lgkmcnt(0)
    v_mfma_f32_16x16x32_bf16 v[64:67], v[116:119], v[212:215], v[64:67]
    v_mfma_f32_16x16x32_bf16 v[68:71], v[132:135], v[212:215], v[68:71]
    s_nop 6
    v_cvt_pk_bf16_f32 v72, v64, v65
    v_cvt_pk_bf16_f32 v73, v66, v67
    v_cvt_pk_bf16_f32 v74, v68, v69
    v_cvt_pk_bf16_f32 v75, v70, v71
    v_lshlrev_b32 v64, 16, v72
    v_and_b32 v65, s48, v72
    v_lshlrev_b32 v66, 16, v73
    v_and_b32 v67, s48, v73
    v_lshlrev_b32 v68, 16, v74
    v_and_b32 v69, s48, v74
    v_lshlrev_b32 v70, 16, v75
    v_and_b32 v71, s48, v75
    v_pk_mul_f32 v[64:65], v[64:65], v[100:101] op_sel_hi:[1,0]
    v_pk_mul_f32 v[66:67], v[66:67], v[100:101] op_sel_hi:[1,0]
    v_pk_mul_f32 v[68:69], v[68:69], v[100:101] op_sel_hi:[1,0]
    v_pk_mul_f32 v[70:71], v[70:71], v[100:101] op_sel_hi:[1,0]
    v_cvt_pk_bf16_f32 v72, v64, v65
    v_cvt_pk_bf16_f32 v73, v66, v67
    v_cvt_pk_bf16_f32 v74, v68, v69
    v_cvt_pk_bf16_f32 v75, v70, v71
    v_lshlrev_b32 v64, 16, v72
    v_and_b32 v65, s48, v72
    v_lshlrev_b32 v66, 16, v73
    v_and_b32 v67, s48, v73
    v_lshlrev_b32 v68, 16, v74
    v_and_b32 v69, s48, v74
    v_lshlrev_b32 v70, 16, v75
    v_and_b32 v71, s48, v75
    v_max3_f32 v96, v64, v65, v66
    v_max3_f32 v98, v67, v68, v69
    v_max3_f32 v96, v96, v70, v71
    v_max_f32 v96, v96, v98
    v_mov_b32 v98, v96
    s_nop 1
    v_permlane16_swap_b32 v96, v98
    v_max_f32 v96, v96, v98
    v_mov_b32 v98, v96
    s_nop 1
    v_permlane32_swap_b32 v96, v98
    v_max_f32 v96, v96, v98
    v_mul_f32 v96, v96, v102
    v_pk_fma_f32 v[64:65], v[64:65], v[102:103], v[96:97] op_sel_hi:[1,0,0] neg_lo:[0,0,1] neg_hi:[0,0,1]
    v_pk_fma_f32 v[66:67], v[66:67], v[102:103], v[96:97] op_sel_hi:[1,0,0] neg_lo:[0,0,1] neg_hi:[0,0,1]
    v_pk_fma_f32 v[68:69], v[68:69], v[102:103], v[96:97] op_sel_hi:[1,0,0] neg_lo:[0,0,1] neg_hi:[0,0,1]
    v_pk_fma_f32 v[70:71], v[70:71], v[102:103], v[96:97] op_sel_hi:[1,0,0] neg_lo:[0,0,1] neg_hi:[0,0,1]
    v_exp_f32 v64, v64
    v_exp_f32 v65, v65
    v_exp_f32 v66, v66
    v_exp_f32 v67, v67
    v_exp_f32 v68, v68
    v_exp_f32 v69, v69
    v_exp_f32 v70, v70
    v_exp_f32 v71, v71
    v_cvt_pk_bf16_f32 v72, v64, v65
    v_cvt_pk_bf16_f32 v73, v66, v67
    v_cvt_pk_bf16_f32 v74, v68, v69
    v_cvt_pk_bf16_f32 v75, v70, v71
    ds_write_b128 v27, v[72:75]
    v_pk_add_f32 v[64:65], v[64:65], v[66:67]
    v_pk_add_f32 v[68:69], v[68:69], v[70:71]
    v_pk_add_f32 v[64:65], v[64:65], v[68:69]
    v_add_f32 v97, v64, v65
    v_mov_b32 v98, v97
    s_nop 1
    v_permlane16_swap_b32 v97, v98
    v_add_f32 v97, v97, v98
    v_mov_b32 v98, v97
    s_nop 1
    v_permlane32_swap_b32 v97, v98
    v_add_f32 v97, v97, v98
    ds_write_b64 v29, v[96:97]
    v_mov_b32 v240, 5
    ds_write_b32 v8, v240
    s_movk_i32 s54, 100
L_lc25:
    ds_read_b32 v240, v7 offset:24
    s_waitcnt lgkmcnt(0)
    v_cmp_gt_i32 vcc, s54, v240
    s_cbranch_vccnz L_lc25
    ds_read_b64_tr_b16 v[136:137], v17 offset:0
    ds_read_b64_tr_b16 v[138:139], v17 offset:4096
    ds_read_b64_tr_b16 v[140:141], v18 offset:0
    ds_read_b64_tr_b16 v[142:143], v18 offset:4096
    ds_read_b64_tr_b16 v[144:145], v17 offset:8192
    ds_read_b64_tr_b16 v[146:147], v17 offset:12288
    ds_read_b64_tr_b16 v[148:149], v18 offset:8192
    ds_read_b64_tr_b16 v[150:151], v18 offset:12288
    ds_read_b64_tr_b16 v[152:153], v17 offset:16384
    ds_read_b64_tr_b16 v[154:155], v17 offset:20480
    ds_read_b64_tr_b16 v[156:157], v18 offset:16384
    ds_read_b64_tr_b16 v[158:159], v18 offset:20480
    ds_read_b64_tr_b16 v[160:161], v17 offset:24576
    ds_read_b64_tr_b16 v[162:163], v17 offset:28672
    ds_read_b64_tr_b16 v[164:165], v18 offset:24576
    ds_read_b64_tr_b16 v[166:167], v18 offset:28672
    s_lshl_b32 s41, s38, 11
    s_add_u32 s41, s41, 0x100000
    s_lshl_b32 s42, s38, 8
    s_add_u32 s42, s42, 0x80000
    s_mov_b32 s43, 0xfffe0000
    s_mov_b32 s44, 0x10000
    s_bitcmp1_b32 s36, 0
    s_mov_b32 s45, 0x00f000f0
    s_cselect_b32 s45, 0x000f000f, s45
L_pw26:
    ds_read_b128 v[240:243], v7
    s_waitcnt lgkmcnt(0)
    v_min3_i32 v240, v240, v241, v242
    v_min_i32 v240, v240, v243
    v_cmp_gt_i32 vcc, 5, v240
    s_cbranch_vccnz L_pw26
    ds_read_b128 v[200:203], v28 offset:0
    ds_read_b128 v[204:207], v28 offset:1024
    ds_read_b128 v[208:211], v28 offset:2048
    ds_read_b128 v[212:215], v28 offset:3072
    ds_read_b64 v[80:81], v30 offset:0
    ds_read_b64 v[82:83], v30 offset:64
    ds_read_b64 v[84:85], v30 offset:128
    ds_read_b64 v[86:87], v30 offset:192
    s_waitcnt lgkmcnt(7)
    v_mfma_f32_16x16x32_bf16 v[168:171], v[136:139], v[200:203], 0
    v_mfma_f32_16x16x32_bf16 v[172:175], v[140:143], v[200:203], 0
    s_waitcnt lgkmcnt(6)
    v_mfma_f32_16x16x32_bf16 v[176:179], v[144:147], v[204:207], 0
    v_mfma_f32_16x16x32_bf16 v[180:183], v[148:151], v[204:207], 0
    s_waitcnt lgkmcnt(5)
    v_mfma_f32_16x16x32_bf16 v[184:187], v[152:155], v[208:211], 0
    v_mfma_f32_16x16x32_bf16 v[188:191], v[156:159], v[208:211], 0
    s_waitcnt lgkmcnt(4)
    v_mfma_f32_16x16x32_bf16 v[192:195], v[160:163], v[212:215], 0
    v_mfma_f32_16x16x32_bf16 v[196:199], v[164:167], v[212:215], 0
    s_waitcnt lgkmcnt(0)
    v_max3_f32 v96, v80, v82, v84
    v_max_f32 v96, v96, v86
    v_sub_f32 v80, v80, v96
    v_sub_f32 v82, v82, v96
    v_sub_f32 v84, v84, v96
    v_sub_f32 v86, v86, v96
    v_exp_f32 v80, v80
    v_exp_f32 v82, v82
    v_exp_f32 v84, v84
    v_exp_f32 v86, v86
    v_mul_f32 v97, v80, v81
    v_fmac_f32 v97, v82, v83
    v_fmac_f32 v97, v84, v85
    v_fmac_f32 v97, v86, v87
    v_rcp_f32 v98, v97
    v_log_f32 v99, v97
    v_mul_f32 v80, v80, v98
    v_mul_f32 v82, v82, v98
    v_mul_f32 v84, v84, v98
    v_mul_f32 v86, v86, v98
    v_pk_mul_f32 v[168:169], v[168:169], v[80:81] op_sel_hi:[1,0]
    v_pk_mul_f32 v[170:171], v[170:171], v[80:81] op_sel_hi:[1,0]
    v_pk_mul_f32 v[172:173], v[172:173], v[80:81] op_sel_hi:[1,0]
    v_pk_mul_f32 v[174:175], v[174:175], v[80:81] op_sel_hi:[1,0]
    v_pk_fma_f32 v[168:169], v[176:177], v[82:83], v[168:169] op_sel_hi:[1,0,1]
    v_pk_fma_f32 v[170:171], v[178:179], v[82:83], v[170:171] op_sel_hi:[1,0,1]
    v_pk_fma_f32 v[172:173], v[180:181], v[82:83], v[172:173] op_sel_hi:[1,0,1]
    v_pk_fma_f32 v[174:175], v[182:183], v[82:83], v[174:175] op_sel_hi:[1,0,1]
    v_pk_fma_f32 v[168:169], v[184:185], v[84:85], v[168:169] op_sel_hi:[1,0,1]
    v_pk_fma_f32 v[170:171], v[186:187], v[84:85], v[170:171] op_sel_hi:[1,0,1]
    v_pk_fma_f32 v[172:173], v[188:189], v[84:85], v[172:173] op_sel_hi:[1,0,1]
    v_pk_fma_f32 v[174:175], v[190:191], v[84:85], v[174:175] op_sel_hi:[1,0,1]
    v_pk_fma_f32 v[168:169], v[192:193], v[86:87], v[168:169] op_sel_hi:[1,0,1]
    v_pk_fma_f32 v[170:171], v[194:195], v[86:87], v[170:171] op_sel_hi:[1,0,1]
    v_pk_fma_f32 v[172:173], v[196:197], v[86:87], v[172:173] op_sel_hi:[1,0,1]
    v_pk_fma_f32 v[174:175], v[198:199], v[86:87], v[174:175] op_sel_hi:[1,0,1]
    v_add_u32 v168, s44, v168
    v_add_u32 v170, s44, v170
    v_add_u32 v172, s44, v172
    v_add_u32 v174, s44, v174
    v_and_b32 v168, s43, v168
    v_and_b32 v170, s43, v170
    v_and_b32 v172, s43, v172
    v_and_b32 v174, s43, v174
    v_cvt_pk_bf16_f32 v64, v168, v169
    v_cvt_pk_bf16_f32 v65, v170, v171
    v_cvt_pk_bf16_f32 v66, v172, v173
    v_cvt_pk_bf16_f32 v67, v174, v175
    v_or_b32 v64, v39, v64
    v_or_b32 v65, v40, v65
    v_or_b32 v66, v41, v66
    v_or_b32 v67, v42, v67
    v_add_f32 v68, v96, v99
    v_mov_b32 v69, s34
    s_and_b32 exec_lo, s6, s45
    s_mov_b32 exec_hi, exec_lo
    s_cbranch_execz L_vm27
    buffer_store_dwordx4 v[64:67], v31, s[24:27], s41 offen sc1
L_vm27:
    s_xor_b32 s45, s45, 0x00ff00ff
    s_and_b32 exec_lo, s6, s45
    s_mov_b32 exec_hi, exec_lo
    s_cbranch_execz L_vm28
    buffer_store_dwordx4 v[64:67], v31, s[24:27], s41 offen
L_vm28:
    s_and_b32 exec_lo, s6, 0xff00ff
    s_mov_b32 exec_hi, exec_lo
    s_cmp_lg_u32 s40, 0
    s_cbranch_scc1 L_nolse
    s_and_b32 exec_lo, s6, 0xff
    s_and_b32 exec_hi, s6, 0x0
    s_cbranch_execz L_vm29
    buffer_store_dwordx2 v[68:69], v32, s[24:27], s42 offen offset:128 sc1
    buffer_store_dwordx2 v[68:69], v32, s[24:27], s42 offen
L_vm29:
    v_add_u32 v100, 146688, v32
    ds_write_b64 v100, v[68:69]
    s_and_b32 exec_lo, s6, 0xff00ff
    s_mov_b32 exec_hi, exec_lo
L_nolse:
    v_add_u32 v100, 144640, v31
    ds_write_b128 v100, v[64:67]
    s_mov_b64 exec, s[6:7]
    v_mov_b32 v240, 6
    ds_write_b32 v8, v240
    s_cbranch_execz L_areal
L_partB:
    s_mov_b32 s35, 0
    s_cmp_ge_u32 s40, 2
    s_cbranch_scc1 L_sig7
    s_xor_b32 s42, s36, s40
    s_lshl_b32 s41, s42, 16
    s_lshl_b32 s45, s42, 13
    s_lshl_b32 s42, s40, 7
    s_add_u32 s45, s45, s42
    s_bfe_u32 s42, s38, 0x20002
    s_lshl_b32 s42, s42, 9
    s_add_u32 s41, s41, s42
    s_bfe_u32 s42, s38, 0x20004
    s_lshl_b32 s43, s42, 7
    s_add_u32 s41, s41, s43
    s_add_u32 s41, s41, 0x100000
    s_lshl_b32 s42, s42, 4
    s_add_u32 s45, s45, s42
    s_add_u32 s45, s45, 0x80000
    s_add_u32 s53, s45, 4096
    s_add_u32 s42, s41, 16384
    s_add_u32 s43, s41, 32768
    s_add_u32 s44, s41, 49152
    s_mul_i32 s57, s40, 12
    s_add_u32 s54, s57, 148
L_lc30:
    ds_read_b32 v240, v7 offset:24
    s_waitcnt lgkmcnt(0)
    v_cmp_gt_i32 vcc, s54, v240
    s_cbranch_vccnz L_lc30
    s_cbranch_execz L_vm31
    buffer_load_dwordx4 v[216:219], v33, s[24:27], s41 offen sc1
    buffer_load_dwordx4 v[220:223], v33, s[24:27], s42 offen sc1
    buffer_load_dwordx4 v[224:227], v33, s[24:27], s43 offen sc1
    buffer_load_dwordx4 v[228:231], v33, s[24:27], s44 offen sc1
    buffer_load_dwordx2 v[232:233], v34, s[24:27], s45 offen offset:0 sc1
    buffer_load_dwordx2 v[234:235], v34, s[24:27], s45 offen offset:2048 sc1
    buffer_load_dwordx2 v[236:237], v34, s[24:27], s53 offen offset:0 sc1
    buffer_load_dwordx2 v[238:239], v34, s[24:27], s53 offen offset:2048 sc1
L_vm31:
    v_mov_b32 v240, 7
    ds_write_b32 v8, v240
    s_movk_i32 s54, 164
L_lc32:
    ds_read_b32 v240, v7 offset:24
    s_waitcnt lgkmcnt(0)
    v_cmp_gt_i32 vcc, s54, v240
    s_cbranch_vccnz L_lc32
    ds_read_b64_tr_b16 v[136:137], v9 offset:0
    ds_read_b64_tr_b16 v[138:139], v9 offset:8192
    ds_read_b64_tr_b16 v[140:141], v10 offset:0
    ds_read_b64_tr_b16 v[142:143], v10 offset:8192
    ds_read_b64_tr_b16 v[144:145], v11 offset:0
    ds_read_b64_tr_b16 v[146:147], v11 offset:8192
    ds_read_b64_tr_b16 v[148:149], v12 offset:0
    ds_read_b64_tr_b16 v[150:151], v12 offset:8192
    v_xor_b32 v9, 0x4000, v9
    v_xor_b32 v10, 0x4000, v10
    v_xor_b32 v11, 0x4000, v11
    v_xor_b32 v12, 0x4000, v12
    ds_read_b64_tr_b16 v[152:153], v9 offset:0
    ds_read_b64_tr_b16 v[154:155], v9 offset:8192
    ds_read_b64_tr_b16 v[156:157], v10 offset:0
    ds_read_b64_tr_b16 v[158:159], v10 offset:8192
    ds_read_b64_tr_b16 v[160:161], v11 offset:0
    ds_read_b64_tr_b16 v[162:163], v11 offset:8192
    ds_read_b64_tr_b16 v[164:165], v12 offset:0
    ds_read_b64_tr_b16 v[166:167], v12 offset:8192
    v_xor_b32 v9, 0x4000, v9
    v_xor_b32 v10, 0x4000, v10
    v_xor_b32 v11, 0x4000, v11
    v_xor_b32 v12, 0x4000, v12
    s_cbranch_execz L_vm33
    s_waitcnt vmcnt(0)
L_vm33:
L_g2chk:
    v_xor_b32 v216, v43, v216
    v_xor_b32 v217, v44, v217
    v_xor_b32 v218, v45, v218
    v_xor_b32 v219, v46, v219
    v_xor_b32 v220, v43, v220
    v_xor_b32 v221, v44, v221
    v_xor_b32 v222, v45, v222
    v_xor_b32 v223, v46, v223
    v_xor_b32 v224, v43, v224
    v_xor_b32 v225, v44, v225
    v_xor_b32 v226, v45, v226
    v_xor_b32 v227, v46, v227
    v_xor_b32 v228, v43, v228
    v_xor_b32 v229, v44, v229
    v_xor_b32 v230, v45, v230
    v_xor_b32 v231, v46, v231
    v_xor_b32 v233, s34, v233
    v_xor_b32 v235, s34, v235
    v_xor_b32 v237, s34, v237
    v_xor_b32 v239, s34, v239
    v_or3_b32 v96, v216, v217, v218
    v_or3_b32 v96, v96, v219, v220
    v_or3_b32 v96, v96, v221, v222
    v_or3_b32 v96, v96, v223, v224
    v_or3_b32 v96, v96, v225, v226
    v_or3_b32 v96, v96, v227, v228
    v_or3_b32 v96, v96, v229, v230
    v_or_b32 v96, v96, v231
    v_or3_b32 v97, v233, v235, v237
    v_and_b32 v96, 1, v96
    v_or_b32 v97, v97, v239
    v_and_or_b32 v96, v97, -8, v96
    v_cmp_ne_u32 vcc, 0, v96
    s_cbranch_vccz L_g2ok
    s_add_u32 s51, s51, 256
    s_sub_u32 s49, s49, 1
    s_cbranch_scc1 L_bail
    s_bfe_u32 s54, s51, 0x80008
    s_cmp_lt_u32 s54, 3
    s_cbranch_scc1 L_nr34
    s_or_b32 s54, s35, s40
    s_cbranch_scc1 L_rs35
    s_mov_b32 s35, 1
L_pw36:
    ds_read_b128 v[240:243], v7
    s_waitcnt lgkmcnt(0)
    v_min3_i32 v240, v240, v241, v242
    v_min_i32 v240, v240, v243
    v_cmp_gt_i32 vcc, 6, v240
    s_cbranch_vccnz L_pw36
    v_lshlrev_b32 v48, 4, v1
    v_add_u32 v49, 144640, v48
    v_lshlrev_b32 v50, 3, v1
    v_add_u32 v51, 146688, v50
    ds_read_b128 v[52:55], v49
    ds_read_b128 v[56:59], v49 offset:1024
    ds_read_b64 v[60:61], v51
    s_lshl_b32 s54, s38, 11
    s_add_u32 s54, s54, 0x100000
    s_waitcnt lgkmcnt(0)
    buffer_store_dwordx4 v[52:55], v48, s[24:27], s54 offen sc1
    buffer_store_dwordx4 v[56:59], v48, s[24:27], s54 offen offset:1024 sc1
    s_lshl_b32 s54, s38, 8
    s_add_u32 s54, s54, 0x80000
    s_mov_b64 exec, 0xff
    buffer_store_dwordx2 v[60:61], v50, s[24:27], s54 offen sc1
    s_mov_b64 exec, -1
L_rs35:
L_nr34:
    s_cbranch_execz L_vm37
    buffer_load_dwordx4 v[216:219], v33, s[24:27], s41 offen sc1
    buffer_load_dwordx4 v[220:223], v33, s[24:27], s42 offen sc1
    buffer_load_dwordx4 v[224:227], v33, s[24:27], s43 offen sc1
    buffer_load_dwordx4 v[228:231], v33, s[24:27], s44 offen sc1
    buffer_load_dwordx2 v[232:233], v34, s[24:27], s45 offen offset:0 sc1
    buffer_load_dwordx2 v[234:235], v34, s[24:27], s45 offen offset:2048 sc1
    buffer_load_dwordx2 v[236:237], v34, s[24:27], s53 offen offset:0 sc1
    buffer_load_dwordx2 v[238:239], v34, s[24:27], s53 offen offset:2048 sc1
L_vm37:
    s_waitcnt vmcnt(0)
    s_branch L_g2chk
L_g2ok:
    v_and_b32 v96, 7, v97
    v_cmp_ne_u32 vcc, 0, v96
    s_cbranch_vccz L_alllocal2
    s_or_b32 s54, s35, s40
    s_cbranch_scc1 L_rs38
    s_mov_b32 s35, 1
L_pw39:
    ds_read_b128 v[240:243], v7
    s_waitcnt lgkmcnt(0)
    v_min3_i32 v240, v240, v241, v242
    v_min_i32 v240, v240, v243
    v_cmp_gt_i32 vcc, 6, v240
    s_cbranch_vccnz L_pw39
    v_lshlrev_b32 v48, 4, v1
    v_add_u32 v49, 144640, v48
    v_lshlrev_b32 v50, 3, v1
    v_add_u32 v51, 146688, v50
    ds_read_b128 v[52:55], v49
    ds_read_b128 v[56:59], v49 offset:1024
    ds_read_b64 v[60:61], v51
    s_lshl_b32 s54, s38, 11
    s_add_u32 s54, s54, 0x100000
    s_waitcnt lgkmcnt(0)
    buffer_store_dwordx4 v[52:55], v48, s[24:27], s54 offen sc1
    buffer_store_dwordx4 v[56:59], v48, s[24:27], s54 offen offset:1024 sc1
    s_lshl_b32 s54, s38, 8
    s_add_u32 s54, s54, 0x80000
    s_mov_b64 exec, 0xff
    buffer_store_dwordx2 v[60:61], v50, s[24:27], s54 offen sc1
    s_mov_b64 exec, -1
L_rs38:
L_alllocal2:
    v_max3_f32 v96, v232, v234, v236
    v_max_f32 v96, v96, v238
    v_lshlrev_b32 v64, 16, v216
    v_and_b32 v65, s48, v216
    v_max_f32_dpp v96, v96, v96 row_ror:8 row_mask:0xf bank_mask:0xf
    v_mov_b32 v98, v96
    v_lshlrev_b32 v66, 16, v217
    v_and_b32 v67, s48, v217
    v_permlane16_swap_b32 v96, v98
    v_max_f32 v96, v96, v98
    v_mov_b32 v98, v96
    v_lshlrev_b32 v68, 16, v218
    v_and_b32 v69, s48, v218
    v_permlane32_swap_b32 v96, v98
    v_max_f32 v96, v96, v98
    v_sub_f32 v232, v232, v96
    v_sub_f32 v234, v234, v96
    v_sub_f32 v236, v236, v96
    v_sub_f32 v238, v238, v96
    v_exp_f32 v232, v232
    v_exp_f32 v234, v234
    v_exp_f32 v236, v236
    v_exp_f32 v238, v238
    v_lshlrev_b32 v70, 16, v219
    v_and_b32 v71, s48, v219
    v_lshlrev_b32 v72, 16, v220
    v_and_b32 v73, s48, v220
    v_lshlrev_b32 v74, 16, v221
    v_and_b32 v75, s48, v221
    v_lshlrev_b32 v76, 16, v222
    v_and_b32 v77, s48, v222
    v_lshlrev_b32 v78, 16, v223
    v_and_b32 v79, s48, v223
    v_lshlrev_b32 v80, 16, v224
    v_and_b32 v81, s48, v224
    v_lshlrev_b32 v82, 16, v225
    v_and_b32 v83, s48, v225
    v_lshlrev_b32 v84, 16, v226
    v_and_b32 v85, s48, v226
    v_lshlrev_b32 v86, 16, v227
    v_and_b32 v87, s48, v227
    v_lshlrev_b32 v88, 16, v228
    v_and_b32 v89, s48, v228
    v_lshlrev_b32 v90, 16, v229
    v_and_b32 v91, s48, v229
    v_lshlrev_b32 v92, 16, v230
    v_and_b32 v93, s48, v230
    v_lshlrev_b32 v94, 16, v231
    v_and_b32 v95, s48, v231
    v_add_f32 v97, v232, v234
    v_add_f32 v98, v236, v238
    v_add_f32 v97, v97, v98
    v_pk_mul_f32 v[64:65], v[64:65], v[232:233] op_sel_hi:[1,0]
    v_pk_mul_f32 v[66:67], v[66:67], v[232:233] op_sel_hi:[1,0]
    v_pk_mul_f32 v[68:69], v[68:69], v[232:233] op_sel_hi:[1,0]
    v_pk_mul_f32 v[70:71], v[70:71], v[232:233] op_sel_hi:[1,0]
    v_add_f32_dpp v97, v97, v97 row_ror:8 row_mask:0xf bank_mask:0xf
    v_pk_fma_f32 v[64:65], v[72:73], v[234:235], v[64:65] op_sel_hi:[1,0,1]
    v_pk_fma_f32 v[66:67], v[74:75], v[234:235], v[66:67] op_sel_hi:[1,0,1]
    v_pk_fma_f32 v[68:69], v[76:77], v[234:235], v[68:69] op_sel_hi:[1,0,1]
    v_pk_fma_f32 v[70:71], v[78:79], v[234:235], v[70:71] op_sel_hi:[1,0,1]
    v_mov_b32 v98, v97
    v_pk_fma_f32 v[64:65], v[80:81], v[236:237], v[64:65] op_sel_hi:[1,0,1]
    v_pk_fma_f32 v[66:67], v[82:83], v[236:237], v[66:67] op_sel_hi:[1,0,1]
    v_pk_fma_f32 v[68:69], v[84:85], v[236:237], v[68:69] op_sel_hi:[1,0,1]
    v_pk_fma_f32 v[70:71], v[86:87], v[236:237], v[70:71] op_sel_hi:[1,0,1]
    v_permlane16_swap_b32 v97, v98
    v_add_f32 v97, v97, v98
    v_mov_b32 v98, v97
    v_pk_fma_f32 v[64:65], v[88:89], v[238:239], v[64:65] op_sel_hi:[1,0,1]
    v_pk_fma_f32 v[66:67], v[90:91], v[238:239], v[66:67] op_sel_hi:[1,0,1]
    v_pk_fma_f32 v[68:69], v[92:93], v[238:239], v[68:69] op_sel_hi:[1,0,1]
    v_pk_fma_f32 v[70:71], v[94:95], v[238:239], v[70:71] op_sel_hi:[1,0,1]
    v_permlane32_swap_b32 v97, v98
    v_add_f32 v97, v97, v98
    v_permlane32_swap_b32 v64, v68
    v_permlane32_swap_b32 v65, v69
    v_permlane32_swap_b32 v66, v70
    v_permlane32_swap_b32 v67, v71
    v_rcp_f32 v97, v97
    v_pk_add_f32 v[64:65], v[64:65], v[68:69]
    v_pk_add_f32 v[66:67], v[66:67], v[70:71]
    s_mov_b32 vcc_lo, 0xff00ff00
    s_mov_b32 vcc_hi, vcc_lo
    v_permlane16_swap_b32 v64, v66
    v_permlane16_swap_b32 v65, v67
    v_pk_add_f32 v[64:65], v[64:65], v[66:67]
    v_cndmask_b32 v66, v64, v65, vcc
    v_cndmask_b32 v67, v65, v64, vcc
    s_nop 1
    v_add_f32_dpp v66, v67, v66 row_ror:8 row_mask:0xf bank_mask:0xf
    v_mul_f32 v66, v66, v97
    v_cvt_pk_bf16_f32 v66, v66, v66
    ds_write_b16 v36, v66
    v_mov_b32 v240, 8
    ds_write_b32 v8, v240
    s_branch L_tail
L_sig7:
    v_mov_b32 v240, 8
    ds_write_b32 v8, v240
    s_movk_i32 s54, 164
L_lc40:
    ds_read_b32 v240, v7 offset:24
    s_waitcnt lgkmcnt(0)
    v_cmp_gt_i32 vcc, s54, v240
    s_cbranch_vccnz L_lc40
    ds_read_b64_tr_b16 v[136:137], v9 offset:0
    ds_read_b64_tr_b16 v[138:139], v9 offset:8192
    ds_read_b64_tr_b16 v[140:141], v10 offset:0
    ds_read_b64_tr_b16 v[142:143], v10 offset:8192
    ds_read_b64_tr_b16 v[144:145], v11 offset:0
    ds_read_b64_tr_b16 v[146:147], v11 offset:8192
    ds_read_b64_tr_b16 v[148:149], v12 offset:0
    ds_read_b64_tr_b16 v[150:151], v12 offset:8192
    v_xor_b32 v9, 0x4000, v9
    v_xor_b32 v10, 0x4000, v10
    v_xor_b32 v11, 0x4000, v11
    v_xor_b32 v12, 0x4000, v12
    ds_read_b64_tr_b16 v[152:153], v9 offset:0
    ds_read_b64_tr_b16 v[154:155], v9 offset:8192
    ds_read_b64_tr_b16 v[156:157], v10 offset:0
    ds_read_b64_tr_b16 v[158:159], v10 offset:8192
    ds_read_b64_tr_b16 v[160:161], v11 offset:0
    ds_read_b64_tr_b16 v[162:163], v11 offset:8192
    ds_read_b64_tr_b16 v[164:165], v12 offset:0
    ds_read_b64_tr_b16 v[166:167], v12 offset:8192
    v_xor_b32 v9, 0x4000, v9
    v_xor_b32 v10, 0x4000, v10
    v_xor_b32 v11, 0x4000, v11
    v_xor_b32 v12, 0x4000, v12
L_tail:
    s_and_b32 s41, s38, 3
    s_lshl_b32 s41, s41, 17
    s_lshr_b32 s42, s38, 2
    s_lshl_b32 s42, s42, 11
    s_add_u32 s41, s41, s42
    s_add_u32 s41, s41, 0x200000
    s_movk_i32 s50, 0xfff
    s_and_b32 s42, s46, s50
    v_mov_b32 v96, s42
    v_xor_b32 v97, 64, v37
    s_movk_i32 s54, 180
L_hw:
    ds_read_b128 v[240:243], v7 offset:16
    s_waitcnt lgkmcnt(0)
    v_min_i32 v240, v240, v241
    v_cmp_gt_i32 vcc, s54, v242
    v_cmp_gt_i32 s[60:61], 1, v240
    s_nop 0
    s_or_b64 vcc, vcc, s[60:61]
    s_cbranch_vccnz L_hw
    ds_read_b128 v[208:211], v37 offset:256
    ds_read_b128 v[212:215], v97 offset:256
    ds_read_b64_tr_b16 v[104:105], v9 offset:32768
    ds_read_b64_tr_b16 v[106:107], v9 offset:40960
    ds_read_b64_tr_b16 v[108:109], v10 offset:32768
    ds_read_b64_tr_b16 v[110:111], v10 offset:40960
    ds_read_b64_tr_b16 v[112:113], v11 offset:32768
    ds_read_b64_tr_b16 v[114:115], v11 offset:40960
    ds_read_b64_tr_b16 v[116:117], v12 offset:32768
    ds_read_b64_tr_b16 v[118:119], v12 offset:40960
    v_xor_b32 v9, 0x4000, v9
    v_xor_b32 v10, 0x4000, v10
    v_xor_b32 v11, 0x4000, v11
    v_xor_b32 v12, 0x4000, v12
    s_waitcnt lgkmcnt(6)
    v_mfma_f32_16x16x32_bf16 v[168:171], v[104:107], v[208:211], 0
    s_waitcnt lgkmcnt(4)
    v_mfma_f32_16x16x32_bf16 v[172:175], v[108:111], v[208:211], 0
    s_waitcnt lgkmcnt(2)
    v_mfma_f32_16x16x32_bf16 v[176:179], v[112:115], v[208:211], 0
    s_waitcnt lgkmcnt(0)
    v_mfma_f32_16x16x32_bf16 v[180:183], v[116:119], v[208:211], 0
    s_movk_i32 s54, 196
L_race:
    ds_read_b32 v98, v7 offset:24
    ds_read_b128 v[240:243], v7
    s_waitcnt lgkmcnt(0)
    v_cmp_gt_i32 vcc, s54, v98
    s_cbranch_vccz L_wfirst
    v_min3_i32 v240, v240, v241, v242
    v_min_i32 v240, v240, v243
    v_cmp_gt_i32 vcc, 8, v240
    s_cbranch_vccnz L_race
L_ofirst:
    ds_read_b128 v[200:203], v37
    ds_read_b128 v[204:207], v97
    s_waitcnt lgkmcnt(1)
    v_mfma_f32_16x16x32_bf16 v[184:187], v[136:139], v[200:203], 0
    v_mfma_f32_16x16x32_bf16 v[188:191], v[140:143], v[200:203], 0
    v_mfma_f32_16x16x32_bf16 v[192:195], v[144:147], v[200:203], 0
    v_mfma_f32_16x16x32_bf16 v[196:199], v[148:151], v[200:203], 0
    s_waitcnt lgkmcnt(0)
    v_mfma_f32_16x16x32_bf16 v[184:187], v[152:155], v[204:207], v[184:187]
    v_mfma_f32_16x16x32_bf16 v[188:191], v[156:159], v[204:207], v[188:191]
    v_mfma_f32_16x16x32_bf16 v[192:195], v[160:163], v[204:207], v[192:195]
    v_mfma_f32_16x16x32_bf16 v[196:199], v[164:167], v[204:207], v[196:199]
    ds_read_b32 v240, v7 offset:24
    s_nop 4
    v_cndmask_b32 v184, v184, v188, s[62:63]
    v_cndmask_b32 v185, v185, v189, s[62:63]
    v_cndmask_b32 v186, v186, v190, s[62:63]
    v_cndmask_b32 v187, v187, v191, s[62:63]
    v_cndmask_b32 v184, v184, v192, s[64:65]
    v_cndmask_b32 v185, v185, v193, s[64:65]
    v_cndmask_b32 v186, v186, v194, s[64:65]
    v_cndmask_b32 v187, v187, v195, s[64:65]
    v_cndmask_b32 v184, v184, v196, s[66:67]
    v_cndmask_b32 v185, v185, v197, s[66:67]
    v_cndmask_b32 v186, v186, v198, s[66:67]
    v_cndmask_b32 v187, v187, v199, s[66:67]
    s_waitcnt lgkmcnt(0)
    v_cmp_gt_i32 vcc, s54, v240
    s_cbranch_vccz L_wnow
    s_movk_i32 s54, 196
L_lc41:
    ds_read_b32 v240, v7 offset:24
    s_waitcnt lgkmcnt(0)
    v_cmp_gt_i32 vcc, s54, v240
    s_cbranch_vccnz L_lc41
L_wnow:
    ds_read_b64_tr_b16 v[120:121], v9 offset:32768
    ds_read_b64_tr_b16 v[122:123], v9 offset:40960
    ds_read_b64_tr_b16 v[124:125], v10 offset:32768
    ds_read_b64_tr_b16 v[126:127], v10 offset:40960
    ds_read_b64_tr_b16 v[128:129], v11 offset:32768
    ds_read_b64_tr_b16 v[130:131], v11 offset:40960
    ds_read_b64_tr_b16 v[132:133], v12 offset:32768
    ds_read_b64_tr_b16 v[134:135], v12 offset:40960
    s_waitcnt lgkmcnt(6)
    v_mfma_f32_16x16x32_bf16 v[168:171], v[120:123], v[212:215], v[168:171]
    s_waitcnt lgkmcnt(4)
    v_mfma_f32_16x16x32_bf16 v[172:175], v[124:127], v[212:215], v[172:175]
    s_waitcnt lgkmcnt(2)
    v_mfma_f32_16x16x32_bf16 v[176:179], v[128:131], v[212:215], v[176:179]
    s_waitcnt lgkmcnt(0)
    v_mfma_f32_16x16x32_bf16 v[180:183], v[132:135], v[212:215], v[180:183]
    s_nop 3
    v_cndmask_b32 v168, v168, v172, s[62:63]
    v_cndmask_b32 v169, v169, v173, s[62:63]
    v_cndmask_b32 v170, v170, v174, s[62:63]
    v_cndmask_b32 v171, v171, v175, s[62:63]
    v_cndmask_b32 v168, v168, v176, s[64:65]
    v_cndmask_b32 v169, v169, v177, s[64:65]
    v_cndmask_b32 v170, v170, v178, s[64:65]
    v_cndmask_b32 v171, v171, v179, s[64:65]
    v_cndmask_b32 v168, v168, v180, s[66:67]
    v_cndmask_b32 v169, v169, v181, s[66:67]
    v_cndmask_b32 v170, v170, v182, s[66:67]
    v_cndmask_b32 v171, v171, v183, s[66:67]
    s_branch L_accdone
L_wfirst:
    ds_read_b64_tr_b16 v[120:121], v9 offset:32768
    ds_read_b64_tr_b16 v[122:123], v9 offset:40960
    ds_read_b64_tr_b16 v[124:125], v10 offset:32768
    ds_read_b64_tr_b16 v[126:127], v10 offset:40960
    ds_read_b64_tr_b16 v[128:129], v11 offset:32768
    ds_read_b64_tr_b16 v[130:131], v11 offset:40960
    ds_read_b64_tr_b16 v[132:133], v12 offset:32768
    ds_read_b64_tr_b16 v[134:135], v12 offset:40960
    s_waitcnt lgkmcnt(6)
    v_mfma_f32_16x16x32_bf16 v[168:171], v[120:123], v[212:215], v[168:171]
    s_waitcnt lgkmcnt(4)
    v_mfma_f32_16x16x32_bf16 v[172:175], v[124:127], v[212:215], v[172:175]
    s_waitcnt lgkmcnt(2)
    v_mfma_f32_16x16x32_bf16 v[176:179], v[128:131], v[212:215], v[176:179]
    s_waitcnt lgkmcnt(0)
    v_mfma_f32_16x16x32_bf16 v[180:183], v[132:135], v[212:215], v[180:183]
    ds_read_b128 v[240:243], v7
    s_nop 2
    v_cndmask_b32 v168, v168, v172, s[62:63]
    v_cndmask_b32 v169, v169, v173, s[62:63]
    v_cndmask_b32 v170, v170, v174, s[62:63]
    v_cndmask_b32 v171, v171, v175, s[62:63]
    v_cndmask_b32 v168, v168, v176, s[64:65]
    v_cndmask_b32 v169, v169, v177, s[64:65]
    v_cndmask_b32 v170, v170, v178, s[64:65]
    v_cndmask_b32 v171, v171, v179, s[64:65]
    v_cndmask_b32 v168, v168, v180, s[66:67]
    v_cndmask_b32 v169, v169, v181, s[66:67]
    v_cndmask_b32 v170, v170, v182, s[66:67]
    v_cndmask_b32 v171, v171, v183, s[66:67]
    s_waitcnt lgkmcnt(0)
    v_min3_i32 v240, v240, v241, v242
    v_min_i32 v240, v240, v243
    v_cmp_gt_i32 vcc, 8, v240
    s_cbranch_vccz L_onow
L_pw42:
    ds_read_b128 v[240:243], v7
    s_waitcnt lgkmcnt(0)
    v_min3_i32 v240, v240, v241, v242
    v_min_i32 v240, v240, v243
    v_cmp_gt_i32 vcc, 8, v240
    s_cbranch_vccnz L_pw42
L_onow:
    ds_read_b128 v[200:203], v37
    ds_read_b128 v[204:207], v97
    s_waitcnt lgkmcnt(1)
    v_mfma_f32_16x16x32_bf16 v[184:187], v[136:139], v[200:203], 0
    v_mfma_f32_16x16x32_bf16 v[188:191], v[140:143], v[200:203], 0
    v_mfma_f32_16x16x32_bf16 v[192:195], v[144:147], v[200:203], 0
    v_mfma_f32_16x16x32_bf16 v[196:199], v[148:151], v[200:203], 0
    s_waitcnt lgkmcnt(0)
    v_mfma_f32_16x16x32_bf16 v[184:187], v[152:155], v[204:207], v[184:187]
    v_mfma_f32_16x16x32_bf16 v[188:191], v[156:159], v[204:207], v[188:191]
    v_mfma_f32_16x16x32_bf16 v[192:195], v[160:163], v[204:207], v[192:195]
    v_mfma_f32_16x16x32_bf16 v[196:199], v[164:167], v[204:207], v[196:199]
    s_nop 5
    v_cndmask_b32 v184, v184, v188, s[62:63]
    v_cndmask_b32 v185, v185, v189, s[62:63]
    v_cndmask_b32 v186, v186, v190, s[62:63]
    v_cndmask_b32 v187, v187, v191, s[62:63]
    v_cndmask_b32 v184, v184, v192, s[64:65]
    v_cndmask_b32 v185, v185, v193, s[64:65]
    v_cndmask_b32 v186, v186, v194, s[64:65]
    v_cndmask_b32 v187, v187, v195, s[64:65]
    v_cndmask_b32 v184, v184, v196, s[66:67]
    v_cndmask_b32 v185, v185, v197, s[66:67]
    v_cndmask_b32 v186, v186, v198, s[66:67]
    v_cndmask_b32 v187, v187, v199, s[66:67]
    s_cbranch_execz L_ofirst
L_accdone:
    v_pk_add_f32 v[168:169], v[168:169], v[184:185]
    v_pk_add_f32 v[170:171], v[170:171], v[186:187]
    v_bfi_b32 v168, s50, v96, v168
    v_bfi_b32 v169, s50, v96, v169
    v_bfi_b32 v170, s50, v96, v170
    v_bfi_b32 v171, s50, v96, v171
    s_and_b32 exec_lo, s6, 0xff00ff
    s_mov_b32 exec_hi, exec_lo
    s_cbranch_execz L_areal
    buffer_store_dwordx4 v[168:171], v35, s[24:27], s41 offen sc1
L_ablend:
    s_endpgm
L_bail:
    s_mov_b64 exec, -1
    v_mov_b32 v240, 0x7fffffff
    ds_write_b32 v8, v240
    s_waitcnt lgkmcnt(0)
    s_endpgm
L_mlp:
    s_load_dwordx2 s[12:13], s[0:1], 56
    s_cmp_lt_u32 s37, 28
    s_cselect_b32 s14, 7168, 0
    s_mov_b32 s15, 0x20000
    v_pk_add_f32 v[72:73], v[72:73], v[102:103] op_sel_hi:[1,0] neg_lo:[0,1] neg_hi:[0,1]
    v_pk_add_f32 v[74:75], v[74:75], v[102:103] op_sel_hi:[1,0] neg_lo:[0,1] neg_hi:[0,1]
    v_pk_add_f32 v[76:77], v[76:77], v[102:103] op_sel_hi:[1,0] neg_lo:[0,1] neg_hi:[0,1]
    v_pk_add_f32 v[78:79], v[78:79], v[102:103] op_sel_hi:[1,0] neg_lo:[0,1] neg_hi:[0,1]
    v_cvt_pk_bf16_f32 v52, v72, v73
    v_cvt_pk_bf16_f32 v53, v74, v75
    v_cvt_pk_bf16_f32 v54, v76, v77
    v_cvt_pk_bf16_f32 v55, v78, v79
    v_lshlrev_b32 v72, 16, v52
    v_and_b32 v73, s48, v52
    v_lshlrev_b32 v74, 16, v53
    v_and_b32 v75, s48, v53
    v_lshlrev_b32 v76, 16, v54
    v_and_b32 v77, s48, v54
    v_lshlrev_b32 v78, 16, v55
    v_and_b32 v79, s48, v55
    v_pk_mul_f32 v[72:73], v[72:73], v[96:97] op_sel_hi:[1,0]
    v_pk_mul_f32 v[74:75], v[74:75], v[96:97] op_sel_hi:[1,0]
    v_pk_mul_f32 v[76:77], v[76:77], v[96:97] op_sel_hi:[1,0]
    v_pk_mul_f32 v[78:79], v[78:79], v[96:97] op_sel_hi:[1,0]
    v_cvt_pk_bf16_f32 v52, v72, v73
    v_cvt_pk_bf16_f32 v53, v74, v75
    v_cvt_pk_bf16_f32 v54, v76, v77
    v_cvt_pk_bf16_f32 v55, v78, v79
    v_pk_add_f32 v[80:81], v[80:81], v[102:103] op_sel_hi:[1,0] neg_lo:[0,1] neg_hi:[0,1]
    v_pk_add_f32 v[82:83], v[82:83], v[102:103] op_sel_hi:[1,0] neg_lo:[0,1] neg_hi:[0,1]
    v_pk_add_f32 v[84:85], v[84:85], v[102:103] op_sel_hi:[1,0] neg_lo:[0,1] neg_hi:[0,1]
    v_pk_add_f32 v[86:87], v[86:87], v[102:103] op_sel_hi:[1,0] neg_lo:[0,1] neg_hi:[0,1]
    v_cvt_pk_bf16_f32 v56, v80, v81
    v_cvt_pk_bf16_f32 v57, v82, v83
    v_cvt_pk_bf16_f32 v58, v84, v85
    v_cvt_pk_bf16_f32 v59, v86, v87
    v_lshlrev_b32 v80, 16, v56
    v_and_b32 v81, s48, v56
    v_lshlrev_b32 v82, 16, v57
    v_and_b32 v83, s48, v57
    v_lshlrev_b32 v84, 16, v58
    v_and_b32 v85, s48, v58
    v_lshlrev_b32 v86, 16, v59
    v_and_b32 v87, s48, v59
    v_pk_mul_f32 v[80:81], v[80:81], v[96:97] op_sel_hi:[1,0]
    v_pk_mul_f32 v[82:83], v[82:83], v[96:97] op_sel_hi:[1,0]
    v_pk_mul_f32 v[84:85], v[84:85], v[96:97] op_sel_hi:[1,0]
    v_pk_mul_f32 v[86:87], v[86:87], v[96:97] op_sel_hi:[1,0]
    v_cvt_pk_bf16_f32 v56, v80, v81
    v_cvt_pk_bf16_f32 v57, v82, v83
    v_cvt_pk_bf16_f32 v58, v84, v85
    v_cvt_pk_bf16_f32 v59, v86, v87
    v_pk_add_f32 v[88:89], v[88:89], v[102:103] op_sel_hi:[1,0] neg_lo:[0,1] neg_hi:[0,1]
    v_pk_add_f32 v[90:91], v[90:91], v[102:103] op_sel_hi:[1,0] neg_lo:[0,1] neg_hi:[0,1]
    v_pk_add_f32 v[92:93], v[92:93], v[102:103] op_sel_hi:[1,0] neg_lo:[0,1] neg_hi:[0,1]
    v_pk_add_f32 v[94:95], v[94:95], v[102:103] op_sel_hi:[1,0] neg_lo:[0,1] neg_hi:[0,1]
    v_cvt_pk_bf16_f32 v60, v88, v89
    v_cvt_pk_bf16_f32 v61, v90, v91
    v_cvt_pk_bf16_f32 v62, v92, v93
    v_cvt_pk_bf16_f32 v63, v94, v95
    v_lshlrev_b32 v88, 16, v60
    v_and_b32 v89, s48, v60
    v_lshlrev_b32 v90, 16, v61
    v_and_b32 v91, s48, v61
    v_lshlrev_b32 v92, 16, v62
    v_and_b32 v93, s48, v62
    v_lshlrev_b32 v94, 16, v63
    v_and_b32 v95, s48, v63
    v_pk_mul_f32 v[88:89], v[88:89], v[96:97] op_sel_hi:[1,0]
    v_pk_mul_f32 v[90:91], v[90:91], v[96:97] op_sel_hi:[1,0]
    v_pk_mul_f32 v[92:93], v[92:93], v[96:97] op_sel_hi:[1,0]
    v_pk_mul_f32 v[94:95], v[94:95], v[96:97] op_sel_hi:[1,0]
    v_cvt_pk_bf16_f32 v60, v88, v89
    v_cvt_pk_bf16_f32 v61, v90, v91
    v_cvt_pk_bf16_f32 v62, v92, v93
    v_cvt_pk_bf16_f32 v63, v94, v95
    s_call_b64 s[60:61], L_ln
    s_lshl_b32 s57, s56, 11
    s_add_u32 s57, s57, 0x40000
    s_getreg_b32 s34, hwreg(HW_REG_XCC_ID, 0, 3)
    s_and_b32 s41, s46, 0x3f8
    s_or_b32 s34, s34, s41
    s_movk_i32 s32, 1023
    s_movk_i32 s33, 512
    s_mov_b32 s35, 0
    s_and_b32 s41, s40, 1
    s_lshl_b32 s42, s41, 8
    v_lshlrev_b32 v26, 3, v3
    v_lshlrev_b32 v25, 9, v2
    v_lshl_add_u32 v25, v3, 4, v25
    v_add_u32 v25, s42, v25
    s_lshl_b32 s41, s41, 7
    s_add_u32 s41, s41, 144128
    v_and_b32 v96, 3, v3
    v_lshlrev_b32 v96, 4, v96
    v_bfe_u32 v97, v3, 2, 1
    v_lshl_add_u32 v96, v97, 3, v96
    v_lshrrev_b32 v97, 3, v3
    v_lshl_add_u32 v96, v97, 6, v96
    v_add_u32 v27, s41, v96
    s_lshl_b32 s41, s56, 7
    s_waitcnt lgkmcnt(0)
    buffer_load_dwordx2 v[232:233], v26, s[12:15], s41 offen
    buffer_load_dword v200, v25, s[24:27], s57 offen sc1
    s_waitcnt vmcnt(0)
    v_lshlrev_b32 v236, 16, v232
    v_and_b32 v237, s48, v232
    v_lshlrev_b32 v238, 16, v233
    v_and_b32 v239, s48, v233
    s_mov_b64 s[6:7], 0
    s_mov_b64 exec, 0
    s_branch L_mtail
L_mreal:
    s_mov_b64 s[6:7], -1
    s_mov_b64 exec, -1
    s_lshl_b32 s41, s58, 9
    s_add_u32 s43, s57, s41
    s_mov_b32 s53, s43
    s_call_b64 s[60:61], L_proj
L_mtail:
    s_movk_i32 s54, 148
L_lc11:
    ds_read_b32 v240, v7 offset:24
    s_waitcnt lgkmcnt(0)
    v_cmp_gt_i32 vcc, s54, v240
    s_cbranch_vccnz L_lc11
    s_cbranch_execz L_vm12
    buffer_load_dwordx4 v[200:203], v25, s[24:27], s57 offen sc1
L_vm12:
    s_cbranch_execz L_vm13
    s_waitcnt vmcnt(0)
L_vm13:
L_g4chk:
    v_xor_b32 v200, s34, v200
    v_xor_b32 v201, s34, v201
    v_xor_b32 v202, s34, v202
    v_xor_b32 v203, s34, v203
    v_or3_b32 v97, v200, v201, v202
    v_or_b32 v97, v97, v203
    v_and_b32 v96, 0x3f8, v97
    v_cmp_ne_u32 vcc, 0, v96
    s_cbranch_vccz L_g4ok
    s_add_u32 s51, s51, 65536
    s_sub_u32 s49, s49, 1
    s_cbranch_scc1 L_bail
    s_bfe_u32 s54, s51, 0x80010
    s_cmp_lt_u32 s54, 4
    s_cbranch_scc1 L_nr14
    s_cmp_lg_u32 s35, 0
    s_cbranch_scc1 L_rs15
    s_mov_b32 s35, 1
    s_and_b32 exec_lo, s6, 0xf000f
    s_mov_b32 exec_hi, exec_lo
    s_cbranch_execz L_vm16
    buffer_store_dwordx4 v[168:171], v24, s[24:27], s53 offen sc1
L_vm16:
    s_mov_b64 exec, s[6:7]
L_rs15:
L_nr14:
    s_cbranch_execz L_vm17
    buffer_load_dwordx4 v[200:203], v25, s[24:27], s57 offen sc1
L_vm17:
    s_waitcnt vmcnt(0)
    s_branch L_g4chk
L_g4ok:
    v_and_b32 v96, 7, v97
    v_cmp_ne_u32 vcc, 0, v96
    s_cbranch_vccz L_alllocal
    s_cmp_lg_u32 s35, 0
    s_cbranch_scc1 L_rs18
    s_mov_b32 s35, 1
    s_and_b32 exec_lo, s6, 0xf000f
    s_mov_b32 exec_hi, exec_lo
    s_cbranch_execz L_vm19
    buffer_store_dwordx4 v[168:171], v24, s[24:27], s53 offen sc1
L_vm19:
    s_mov_b64 exec, s[6:7]
L_rs18:
    v_and_b32 v200, -8, v200
    v_and_b32 v201, -8, v201
    v_and_b32 v202, -8, v202
    v_and_b32 v203, -8, v203
L_alllocal:
    v_mov_b32 v204, v200
    v_mov_b32 v205, v201
    v_mov_b32 v206, v202
    v_mov_b32 v207, v203
    v_permlane16_swap_b32 v200, v204
    v_permlane16_swap_b32 v201, v205
    v_permlane16_swap_b32 v202, v206
    v_permlane16_swap_b32 v203, v207
    v_add_f32 v200, v200, v204
    v_add_f32 v201, v201, v205
    v_add_f32 v202, v202, v206
    v_add_f32 v203, v203, v207
    v_mov_b32 v204, v200
    v_mov_b32 v205, v201
    v_mov_b32 v206, v202
    v_mov_b32 v207, v203
    v_permlane32_swap_b32 v200, v204
    v_permlane32_swap_b32 v201, v205
    v_permlane32_swap_b32 v202, v206
    v_permlane32_swap_b32 v203, v207
    v_add_f32 v200, v200, v204
    v_add_f32 v201, v201, v205
    v_add_f32 v202, v202, v206
    v_add_f32 v203, v203, v207
    v_cvt_pk_bf16_f32 v204, v200, v201
    v_cvt_pk_bf16_f32 v205, v202, v203
    v_lshlrev_b32 v200, 16, v204
    v_and_b32 v201, s48, v204
    v_lshlrev_b32 v202, 16, v205
    v_and_b32 v203, s48, v205
    v_pk_add_f32 v[200:201], v[200:201], v[236:237]
    v_pk_add_f32 v[202:203], v[202:203], v[238:239]
    v_cvt_pk_bf16_f32 v204, v200, v201
    v_cvt_pk_bf16_f32 v205, v202, v203
    v_lshlrev_b32 v200, 16, v204
    v_and_b32 v201, s48, v204
    v_lshlrev_b32 v202, 16, v205
    v_and_b32 v203, s48, v205
    v_pk_mul_f32 v[204:205], v[200:201], v[200:201]
    v_pk_mul_f32 v[206:207], v[202:203], v[202:203]
    v_mul_f32 v204, 0xbdd2d3e8, v204
    v_mul_f32 v205, 0xbdd2d3e8, v205
    v_mul_f32 v206, 0xbdd2d3e8, v206
    v_mul_f32 v207, 0xbdd2d3e8, v207
    v_add_f32 v204, 0xc0135761, v204
    v_add_f32 v205, 0xc0135761, v205
    v_add_f32 v206, 0xc0135761, v206
    v_add_f32 v207, 0xc0135761, v207
    v_pk_mul_f32 v[204:205], v[204:205], v[200:201]
    v_pk_mul_f32 v[206:207], v[206:207], v[202:203]
    v_exp_f32 v204, v204
    v_exp_f32 v205, v205
    v_exp_f32 v206, v206
    v_exp_f32 v207, v207
    v_add_f32 v204, 1.0, v204
    v_add_f32 v205, 1.0, v205
    v_add_f32 v206, 1.0, v206
    v_add_f32 v207, 1.0, v207
    v_rcp_f32 v204, v204
    v_rcp_f32 v205, v205
    v_rcp_f32 v206, v206
    v_rcp_f32 v207, v207
    v_pk_mul_f32 v[200:201], v[200:201], v[204:205]
    v_pk_mul_f32 v[202:203], v[202:203], v[206:207]
    v_cvt_pk_bf16_f32 v200, v200, v201
    v_cvt_pk_bf16_f32 v201, v202, v203
    ds_write_b64 v27, v[200:201]
    v_mov_b32 v240, 1
    ds_write_b32 v8, v240
    s_cbranch_execz L_mreal
    s_endpgm
L_codeend:
    .fill (L_pc + 16384 - L_codeend + 3) / 4, 4, 0xbf810000
.section .rodata,"a"
.p2align 6
.amdhsa_kernel parallel_sum__sliding_block_cached__mixer_channel_mlp__decode_kernel
  .amdhsa_next_free_vgpr 248
  .amdhsa_next_free_sgpr 102
  .amdhsa_accum_offset 248
  .amdhsa_group_segment_fixed_size 0
  .amdhsa_kernarg_size 104
  .amdhsa_user_sgpr_count 2
  .amdhsa_user_sgpr_kernarg_segment_ptr 1
  .amdhsa_system_sgpr_workgroup_id_x 1
  .amdhsa_float_denorm_mode_32 3
.end_amdhsa_kernel
```
